```python
import torch

def _softmax(x, axis=-1):
    return torch.softmax(x, dim=axis)
def _gelu(x):
    return torch.nn.functional.gelu(x, approximate="tanh")
def _silu(x):
    return torch.nn.functional.silu(x)
def _sigmoid(x):
    return torch.sigmoid(x)
def _layernorm(x, axis=-1, eps=1e-5):
    m = x.mean(dim=axis, keepdim=True)
    v = x.var(dim=axis, keepdim=True, unbiased=False)
    return (x - m) / torch.sqrt(v + eps)
def _scatter_add(tgt, idx, src, axis=0):
    return tgt.clone().index_add_(axis, idx, src)
def _segment_sum(src, seg, n):
    out = torch.zeros((n,) + src.shape[1:], dtype=src.dtype)
    return out.index_add_(0, seg, src)
def _pad(x, pw):
    flat = tuple(v for pair in reversed(pw) for v in pair)
    return torch.nn.functional.pad(x, flat)

kernel_name = 'gather_scatter__hybrid_graph_tf_nagphormer__graph'

def setup_inputs():

    _w = (lambda a: (lambda t: t.to(torch.bfloat16) if t.is_floating_point() else t)(torch.as_tensor(a)))
    N, deg, D = 50000, 16, 64
    E = N * deg
    src = (lambda lo, hi, *s: torch.randint(lo, hi, s))(0, N, E).to(torch.int64)
    dst = (lambda lo, hi, *s: torch.randint(lo, hi, s))(0, N, E).to(torch.int64)
    deg_cnt = torch.bincount(dst, minlength=N).to(float) + 1.0
    sc = 1.0 / D ** 0.5
    return {
        "x": _w((lambda *s: torch.randn(*s, dtype=torch.bfloat16) * 0.1)(N, D)),
        "src": _w(src),
        "dst": _w(dst),
        "deg_inv_sqrt": _w(1.0 / (lambda _x: torch.sqrt(torch.as_tensor(_x)))(deg_cnt)),
        "wq": _w((lambda *s: torch.randn(*s, dtype=torch.bfloat16) * 3.2)(D, D) * sc),
        "wk": _w((lambda *s: torch.randn(*s, dtype=torch.bfloat16) * 3.2)(D, D) * sc),
        "wv": _w((lambda *s: torch.randn(*s, dtype=torch.bfloat16) * 0.1)(D, D) * sc),
        "wo": _w((lambda *s: torch.randn(*s, dtype=torch.bfloat16) * 0.1)(D, D) * sc),
        "w_r": _w((lambda *s: torch.randn(*s, dtype=torch.bfloat16) * 0.1)(D)),
    }

def reference(x, src, dst, deg_inv_sqrt, wq, wk, wv, wo, w_r):
    N, D = x.shape[0], x.shape[1]
    K = 7
    h = x
    toks = [x]
    for _ in range(K):
        msg = h[src] * deg_inv_sqrt[src, None] * deg_inv_sqrt[dst, None]
        h = _segment_sum(msg, dst, N)
        toks.append(h)
    tok = torch.stack(toks, axis=1)
    t = _layernorm(tok, axis=-1)
    q   = torch.einsum('nkd,de->nke', t, wq)
    key = torch.einsum('nkd,de->nke', t, wk)
    v   = torch.einsum('nkd,de->nke', t, wv)
    scale = 1.0 / (D ** 0.5)
    attn = _softmax(torch.einsum('nkd,nld->nkl', q, key) * scale, axis=-1)
    o = torch.einsum('nkl,nld->nkd', attn, v)
    o = tok + torch.einsum('nkd,de->nke', o, wo)
    r = _layernorm(o, axis=-1)
    alpha = _softmax(torch.einsum('nkd,d->nk', r, w_r), axis=-1)
    return torch.einsum('nk,nkd->nd', alpha, o)
```

```asm
; @launch grid=(256,1,1) block=(512,1,1) lds=163840
.amdgcn_target "amdgcn-amd-amdhsa--gfx950"
.text
.globl gather_scatter__hybrid_graph_tf_nagphormer__graph_kernel
.p2align 8
.type gather_scatter__hybrid_graph_tf_nagphormer__graph_kernel,@function
gather_scatter__hybrid_graph_tf_nagphormer__graph_kernel:
    s_cmp_ge_u32 s2, 256
    s_cbranch_scc1 K_END
    s_load_dwordx8 s[20:27], s[0:1], 0
    s_load_dwordx4 s[4:7], s[0:1], 80
    v_readfirstlane_b32 s3, v0
    s_lshr_b32 s3, s3, 6
    v_and_b32 v1, 63, v0
    s_mul_i32 s62, s2, 12512
    v_lshlrev_b32 v27, 4, v0
    v_add_u32 v24, s62, v27
    s_movk_i32 s63, 782
    s_cmp_eq_u32 s2, 255
    s_cselect_b32 s63, 590, s63
    v_add_u32 v25, 448, v0
    v_cmp_gt_u32 s[88:89], s63, v25
    v_mov_b32 v36, 0x80000000
    v_add_u32 v25, 7168, v24
    v_cndmask_b32 v25, v36, v25, s[88:89]
    s_mul_i32 s56, s2, 196
    v_and_b32 v2, 7, v0
    v_lshlrev_b32 v2, 4, v2
    v_lshrrev_b32 v26, 3, v0
    s_waitcnt lgkmcnt(0)
    s_mov_b32 s84, s24
    s_mov_b32 s85, s25
    s_mov_b32 s86, 0x30d400
    s_mov_b32 s87, 0x20000
    s_mov_b32 s80, s22
    s_mov_b32 s81, s23
    s_mov_b32 s82, 0x30d400
    s_mov_b32 s83, 0x20000
    s_mov_b32 s28, s26
    s_mov_b32 s29, s27
    s_mov_b32 s30, 0x186a0
    s_mov_b32 s31, 0x20000
    s_mov_b32 s22, 0x61a800
    s_mov_b32 s23, 0x20000
    s_mov_b32 s32, s4
    s_mov_b32 s33, s5
    s_mov_b32 s34, 0x100
    s_mov_b32 s35, 0x20000
    s_mov_b32 s4, s6
    s_mov_b32 s5, s7
    s_add_u32 s6, s4, 0x3fffff
    s_addc_u32 s7, s5, 0
    s_and_b32 s6, s6, 0xffc00000
    s_cmp_eq_u32 s3, 7
    s_cbranch_scc1 K_NOLOADS
    buffer_load_dwordx4 v[8:11], v24, s[84:87], 0 offen
    buffer_load_dwordx4 v[12:15], v25, s[84:87], 0 offen
    buffer_load_dwordx4 v[16:19], v24, s[80:83], 0 offen
    buffer_load_dwordx4 v[20:23], v25, s[80:83], 0 offen
    s_branch K_LOADED
K_NOLOADS:
    s_add_u32 s16, s6, 0x7100000
    s_addc_u32 s17, s7, 0
    s_mov_b32 s18, 0x80400
    s_mov_b32 s19, 0x20000
    s_cmp_ge_u32 s2, 16
    s_cbranch_scc1 K_NOZ1
    v_lshlrev_b32 v28, 7, v1
    v_mov_b32 v94, 0
    s_mul_i32 s64, s2, 24576
    buffer_store_dword v94, v28, s[16:19], s64 offen sc1
    s_add_u32 s64, s64, 8192
    buffer_store_dword v94, v28, s[16:19], s64 offen sc1
    s_add_u32 s64, s64, 8192
    buffer_store_dword v94, v28, s[16:19], s64 offen sc1
    s_add_u32 s64, s64, 8192
    s_mul_i32 s64, s2, 64
    s_add_u32 s64, s64, 524288
    v_lshlrev_b32 v28, 2, v1
    s_mov_b64 exec, 0xffff
    buffer_store_dword v94, v28, s[16:19], s64 offen sc1
    s_mov_b64 exec, -1
K_NOZ1:
    s_getpc_b64 s[84:85]
    s_mov_b32 s86, CODE_END-K_NOLOADS
    v_lshlrev_b32 v28, 7, v1
    s_lshr_b32 s64, s2, 3
    s_mul_i32 s64, s64, 1536
    s_mov_b64 exec, 0xfff
    buffer_load_dword v95, v28, s[84:87], s64 offen
    s_mov_b64 exec, -1
    s_mov_b32 s24, s6
    s_mov_b32 s25, s7
    s_mov_b32 s26, 0x7c00000
    s_mov_b32 s27, 0x20000
    s_lshl_b32 s64, s2, 7
    s_add_u32 s64, s64, 0x7400000
    v_lshlrev_b32 v28, 21, v1
    v_add_u32 v28, s64, v28
    v_writelane_b32 v28, s64, 4
    s_mul_i32 s64, s2, 20480
    v_writelane_b32 v28, s64, 5
    s_mul_i32 s64, s2, 14848
    s_add_u32 s64, s64, 5242880
    v_writelane_b32 v28, s64, 6
    s_mov_b32 s64, 0x7080000
    v_writelane_b32 v28, s64, 4
    s_mov_b64 exec, 0x7f
    buffer_load_dword v95, v28, s[24:27], 0 offen
    v_mov_b32 v28, 128
    s_mov_b64 exec, 1
    buffer_load_dword v95, v28, s[32:35], 0 offen
    s_mov_b64 exec, -1
K_LOADED:
    s_cmp_eq_u32 s2, 255
    s_cbranch_scc0 K_NOWL
    s_load_dwordx8 s[48:55], s[0:1], 32
    s_load_dwordx2 s[96:97], s[0:1], 64
    v_and_b32 v28, 15, v1
    v_lshrrev_b32 v29, 4, v1
    s_lshr_b32 s64, s3, 1
    s_lshl_b32 s64, s64, 11
    s_and_b32 s65, s3, 1
    v_lshlrev_b32 v30, 7, v28
    v_lshl_add_u32 v30, v29, 4, v30
    s_mov_b32 s10, 8192
    s_mov_b32 s11, 0x20000
    s_waitcnt lgkmcnt(0)
    s_mov_b32 s8, s48
    s_mov_b32 s9, s49
    buffer_load_dwordx4 v[160:163], v30, s[8:11], s64 offen offset:0
    buffer_load_dwordx4 v[164:167], v30, s[8:11], s64 offen offset:64
    s_mov_b32 s8, s52
    s_mov_b32 s9, s53
    buffer_load_dwordx4 v[168:171], v30, s[8:11], s64 offen offset:0
    buffer_load_dwordx4 v[172:175], v30, s[8:11], s64 offen offset:64
    s_mov_b32 s8, s50
    s_mov_b32 s9, s51
    s_lshl_b32 s64, s65, 12
    buffer_load_dwordx4 v[176:179], v30, s[8:11], s64 offen offset:0
    buffer_load_dwordx4 v[180:183], v30, s[8:11], s64 offen offset:64
    buffer_load_dwordx4 v[184:187], v30, s[8:11], s64 offen offset:2048
    buffer_load_dwordx4 v[188:191], v30, s[8:11], s64 offen offset:2112
    s_mov_b32 s8, s54
    s_mov_b32 s9, s55
    buffer_load_dwordx4 v[192:195], v27, s[8:11], 0 offen
    s_mov_b32 s8, s96
    s_mov_b32 s9, s97
    s_movk_i32 s10, 128
    v_lshlrev_b32 v30, 1, v1
    buffer_load_ushort v228, v30, s[8:11], 0 offen
    s_lshl_b32 s64, s65, 6
    v_lshl_add_u32 v30, v29, 3, s64
    buffer_load_dwordx2 v[224:225], v30, s[8:11], 0 offen
    buffer_load_dwordx2 v[226:227], v30, s[8:11], 0 offen offset:32
K_NOWL:
    s_add_u32 s24, s6, 0x7400000
    s_addc_u32 s25, s7, 0
    s_mov_b32 s26, 0x800000
    s_mov_b32 s27, 0x20000
    s_add_u32 s16, s6, 0x7100000
    s_addc_u32 s17, s7, 0
    s_mov_b32 s18, 0x60000
    s_mov_b32 s19, 0x20000
    s_lshr_b32 s72, s2, 2
    s_lshl_b32 s72, s72, 7
    s_mov_b32 s12, s6
    s_mov_b32 s13, s7
    s_mov_b32 s14, 0x8a0000
    s_mov_b32 s15, 0x20000
    s_sub_u32 s8, s6, 0x1000000
    s_subb_u32 s9, s7, 0
    s_mov_b32 s10, 0x8a0000
    s_mov_b32 s11, 0x20000
    v_mov_b32 v32, 0
    v_mov_b32 v40, -1
    v_mov_b32 v33, 0
    v_mov_b32 v41, -1
    v_mov_b32 v34, 0
    v_mov_b32 v42, -1
    v_mov_b32 v35, 0
    v_mov_b32 v43, -1
    v_mov_b32 v37, v36
    v_mov_b32 v38, v36
    v_mov_b32 v39, v36
    ds_write_b128 v27, v[40:43] offset:0
    ds_write_b128 v27, v[40:43] offset:8192
    ds_write_b128 v27, v[40:43] offset:16384
    ds_write_b128 v27, v[40:43] offset:24576
    v_add_u32 v28, 142720, v27
    ds_write_b128 v28, v[36:39]
    ds_write_b128 v28, v[36:39] offset:8192
    ds_write_b128 v27, v[32:35] offset:32768
    v_cmp_gt_u32 vcc, 152, v0
    s_and_saveexec_b64 s[96:97], vcc
    ds_write_b128 v28, v[36:39] offset:16384
    v_cmp_gt_u32 vcc, 128, v0
    s_and_b64 exec, exec, vcc
    ds_write_b128 v27, v[32:35] offset:40960
    v_cmp_gt_u32 vcc, 28, v0
    s_and_b64 exec, exec, vcc
    v_add_u32 v28, 161664, v27
    ds_write_b128 v28, v[32:35]
    s_mov_b64 exec, s[96:97]
    v_subrev_u32 v49, 80, v0
    v_cmp_gt_u32 vcc, 48, v0
    s_nop 1
    v_cndmask_b32 v49, v49, v0, vcc
    v_add_u32 v49, 40960, v49
    v_subrev_u32 v52, 48, v0
    v_cmp_lt_u32 vcc, 87, v0
    s_nop 1
    v_cndmask_b32 v51, 0, 1, vcc
    v_cmp_gt_u32 vcc, 80, v52
    v_mov_b32 v48, 80
    v_mov_b32 v50, 116
    v_cndmask_b32 v48, v50, v48, vcc
    v_cndmask_b32 v49, v49, v52, vcc
    v_mov_b32 v52, 0xffffffc0
    v_cndmask_b32 v50, 0, v52, vcc
    v_or_b32 v52, 0x2002, v51
    v_cndmask_b32 v51, v51, v52, vcc
    v_cmp_gt_u32 vcc, 256, v0
    s_mov_b64 exec, vcc
    ds_write_b128 v27, v[48:51] offset:57344
    s_mov_b64 exec, -1
    v_mov_b32 v85, 0
    v_writelane_b32 v85, 1, 0
    v_writelane_b32 v85, 9, 1
    v_writelane_b32 v85, 17, 2
    v_writelane_b32 v85, 24, 3
    v_writelane_b32 v85, 32, 4
    v_writelane_b32 v85, 40, 5
    v_writelane_b32 v85, 48, 6
    v_writelane_b32 v85, 49, 7
    v_writelane_b32 v85, 41, 8
    v_writelane_b32 v85, 33, 9
    v_writelane_b32 v85, 25, 10
    v_and_b32 v2, 7, v1
    v_lshlrev_b32 v2, 4, v2
    v_lshrrev_b32 v86, 4, v1
    v_and_b32 v87, 1, v86
    v_lshlrev_b32 v87, 2, v87
    v_and_b32 v86, 2, v86
    v_bfe_u32 v88, v1, 3, 1
    v_or3_b32 v86, v86, v87, v88
    s_lshl_b32 s62, s3, 3
    v_add_u32 v87, s62, v86
    v_lshlrev_b32 v4, 4, v87
    v_add_u32 v4, 139520, v4
    v_lshlrev_b32 v5, 5, v87
    v_add_u32 v5, 133124, v5
    v_lshl_add_u32 v6, v86, 7, v2
    v_mov_b32 v45, v36
    v_mov_b32 v112, v36
    v_mov_b32 v113, v36
    v_mov_b32 v114, v36
    v_mov_b32 v115, v36
    v_mov_b32 v116, v36
    v_mov_b32 v117, v36
    v_mov_b32 v118, v36
    v_mov_b32 v119, v36
    s_lshl_b32 s76, s3, 10
    s_add_u32 s77, s76, 109568
    s_mov_b32 s73, 0x3f803f80
    s_mov_b32 s74, 0x42800000
    s_mov_b32 s57, 0
    s_movk_i32 s44, 80
    s_movk_i32 s45, 116
    v_mov_b32 v46, s2
    v_mov_b32 v50, 1
    v_mov_b32 v128, 0
    v_mov_b32 v129, 0
    v_mov_b32 v130, 0
    v_mov_b32 v131, 0
    v_mov_b32 v132, 0
    v_mov_b32 v133, 0
    v_mov_b32 v134, 0
    v_mov_b32 v135, 0
    v_mov_b32 v136, 0
    v_mov_b32 v137, 0
    v_mov_b32 v138, 0
    v_mov_b32 v139, 0
    v_mov_b32 v140, 0
    v_mov_b32 v141, 0
    v_mov_b32 v142, 0
    v_mov_b32 v143, 0
    v_mov_b32 v144, 0
    v_mov_b32 v145, 0
    v_mov_b32 v146, 0
    v_mov_b32 v147, 0
    v_mov_b32 v148, 0
    v_mov_b32 v149, 0
    v_mov_b32 v150, 0
    v_mov_b32 v151, 0
    v_mov_b32 v152, 0
    v_mov_b32 v153, 0
    v_mov_b32 v154, 0
    v_mov_b32 v155, 0
    v_mov_b32 v156, 0
    v_mov_b32 v157, 0
    v_mov_b32 v158, 0
    v_mov_b32 v159, 0
    v_mov_b32 v120, 0
    v_mov_b32 v121, 0
    v_mov_b32 v122, 0
    v_mov_b32 v123, 0
    v_mov_b32 v124, 0
    v_mov_b32 v125, 0
    v_mov_b32 v126, 0
    v_mov_b32 v127, 0
    s_add_u32 s84, s6, 0x7c00000
    s_addc_u32 s85, s7, 0
    s_mov_b32 s86, 0x800000
    s_mov_b32 s87, 0x20000
    s_waitcnt lgkmcnt(0)
    s_barrier
    s_cmp_eq_u32 s3, 7
    s_cbranch_scc1 K_PROBE
    s_waitcnt vmcnt(2)
    v_add_u32 v28, 0, v26
    v_add_u32 v29, s56, v28
    v_lshl_add_u32 v30, v29, 7, v2
    v_lshlrev_b32 v29, 1, v29
    buffer_load_dwordx4 v[64:67], v30, s[20:23], 0 offen
    buffer_load_ushort v80, v29, s[28:31], 0 offen
    v_add_u32 v28, 56, v26
    v_add_u32 v29, s56, v28
    v_lshl_add_u32 v30, v29, 7, v2
    v_lshlrev_b32 v29, 1, v29
    buffer_load_dwordx4 v[68:71], v30, s[20:23], 0 offen
    buffer_load_ushort v81, v29, s[28:31], 0 offen
    v_add_u32 v28, 112, v26
    v_add_u32 v29, s56, v28
    v_lshl_add_u32 v30, v29, 7, v2
    v_lshlrev_b32 v29, 1, v29
    buffer_load_dwordx4 v[72:75], v30, s[20:23], 0 offen
    buffer_load_ushort v82, v29, s[28:31], 0 offen
    v_add_u32 v28, 168, v26
    v_add_u32 v29, s56, v28
    v_lshl_add_u32 v30, v29, 7, v2
    v_lshlrev_b32 v29, 1, v29
    v_cmp_gt_u32 vcc, 196, v28
    s_nop 1
    v_cndmask_b32 v30, v36, v30, vcc
    buffer_load_dwordx4 v[76:79], v30, s[20:23], 0 offen
    buffer_load_ushort v83, v29, s[28:31], 0 offen
    v_add_lshl_u32 v29, v0, s56, 1
    buffer_load_ushort v84, v29, s[28:31], 0 offen
    v_mul_u32_u24 v96, 85599, v8
    v_lshrrev_b32 v96, 24, v96
    v_mul_u32_u24 v28, 196, v96
    v_sub_u32 v8, v8, v28
    v_lshlrev_b32 v28, 2, v96
    ds_add_rtn_u32 v104, v28, v50 offset:32768
    v_mul_u32_u24 v97, 85599, v9
    v_lshrrev_b32 v97, 24, v97
    v_mul_u32_u24 v28, 196, v97
    v_sub_u32 v9, v9, v28
    v_lshlrev_b32 v28, 2, v97
    ds_add_rtn_u32 v105, v28, v50 offset:32768
    v_mul_u32_u24 v98, 85599, v10
    v_lshrrev_b32 v98, 24, v98
    v_mul_u32_u24 v28, 196, v98
    v_sub_u32 v10, v10, v28
    v_lshlrev_b32 v28, 2, v98
    ds_add_rtn_u32 v106, v28, v50 offset:32768
    v_mul_u32_u24 v99, 85599, v11
    v_lshrrev_b32 v99, 24, v99
    v_mul_u32_u24 v28, 196, v99
    v_sub_u32 v11, v11, v28
    v_lshlrev_b32 v28, 2, v99
    ds_add_rtn_u32 v107, v28, v50 offset:32768
    s_mov_b64 exec, s[88:89]
    v_mul_u32_u24 v100, 85599, v12
    v_lshrrev_b32 v100, 24, v100
    v_mul_u32_u24 v28, 196, v100
    v_sub_u32 v12, v12, v28
    v_lshlrev_b32 v28, 2, v100
    ds_add_rtn_u32 v108, v28, v50 offset:32768
    v_mul_u32_u24 v101, 85599, v13
    v_lshrrev_b32 v101, 24, v101
    v_mul_u32_u24 v28, 196, v101
    v_sub_u32 v13, v13, v28
    v_lshlrev_b32 v28, 2, v101
    ds_add_rtn_u32 v109, v28, v50 offset:32768
    v_mul_u32_u24 v102, 85599, v14
    v_lshrrev_b32 v102, 24, v102
    v_mul_u32_u24 v28, 196, v102
    v_sub_u32 v14, v14, v28
    v_lshlrev_b32 v28, 2, v102
    ds_add_rtn_u32 v110, v28, v50 offset:32768
    v_mul_u32_u24 v103, 85599, v15
    v_lshrrev_b32 v103, 24, v103
    v_mul_u32_u24 v28, 196, v103
    v_sub_u32 v15, v15, v28
    v_lshlrev_b32 v28, 2, v103
    ds_add_rtn_u32 v111, v28, v50 offset:32768
    s_mov_b64 exec, -1
    s_waitcnt vmcnt(9)
    v_mul_u32_u24 v28, 85599, v16
    v_lshrrev_b32 v28, 24, v28
    v_mul_u32_u24 v44, 196, v28
    v_sub_u32 v16, v16, v44
    v_lshlrev_b32 v16, 4, v16
    ds_read_b128 v[232:235], v16 offset:57344
    v_mul_u32_u24 v29, 85599, v17
    v_lshrrev_b32 v29, 24, v29
    v_mul_u32_u24 v44, 196, v29
    v_sub_u32 v17, v17, v44
    v_lshlrev_b32 v17, 4, v17
    ds_read_b128 v[236:239], v17 offset:57344
    v_mul_u32_u24 v30, 85599, v18
    v_lshrrev_b32 v30, 24, v30
    v_mul_u32_u24 v44, 196, v30
    v_sub_u32 v18, v18, v44
    v_lshlrev_b32 v18, 4, v18
    ds_read_b128 v[240:243], v18 offset:57344
    v_mul_u32_u24 v31, 85599, v19
    v_lshrrev_b32 v31, 24, v31
    v_mul_u32_u24 v44, 196, v31
    v_sub_u32 v19, v19, v44
    v_lshlrev_b32 v19, 4, v19
    ds_read_b128 v[244:247], v19 offset:57344
    s_waitcnt lgkmcnt(3)
    v_mad_u32_u24 v232, v28, v232, v233
    v_and_b32 v234, v232, v234
    v_add_lshl_u32 v232, v232, v234, 7
    v_lshrrev_b32 v233, 8, v232
    v_or_b32 v233, 3, v233
    v_and_or_b32 v232, v233, v235, v232
    v_lshl_or_b32 v16, v8, 24, v232
    s_waitcnt lgkmcnt(2)
    v_mad_u32_u24 v236, v29, v236, v237
    v_and_b32 v238, v236, v238
    v_add_lshl_u32 v236, v236, v238, 7
    v_lshrrev_b32 v237, 8, v236
    v_or_b32 v237, 3, v237
    v_and_or_b32 v236, v237, v239, v236
    v_lshl_or_b32 v17, v9, 24, v236
    s_waitcnt lgkmcnt(1)
    v_mad_u32_u24 v240, v30, v240, v241
    v_and_b32 v242, v240, v242
    v_add_lshl_u32 v240, v240, v242, 7
    v_lshrrev_b32 v241, 8, v240
    v_or_b32 v241, 3, v241
    v_and_or_b32 v240, v241, v243, v240
    v_lshl_or_b32 v18, v10, 24, v240
    s_waitcnt lgkmcnt(0)
    v_mad_u32_u24 v244, v31, v244, v245
    v_and_b32 v246, v244, v246
    v_add_lshl_u32 v244, v244, v246, 7
    v_lshrrev_b32 v245, 8, v244
    v_or_b32 v245, 3, v245
    v_and_or_b32 v244, v245, v247, v244
    v_lshl_or_b32 v19, v11, 24, v244
    v_mul_u32_u24 v28, 85599, v20
    v_lshrrev_b32 v28, 24, v28
    v_mul_u32_u24 v44, 196, v28
    v_sub_u32 v20, v20, v44
    v_lshlrev_b32 v20, 4, v20
    ds_read_b128 v[232:235], v20 offset:57344
    v_mul_u32_u24 v29, 85599, v21
    v_lshrrev_b32 v29, 24, v29
    v_mul_u32_u24 v44, 196, v29
    v_sub_u32 v21, v21, v44
    v_lshlrev_b32 v21, 4, v21
    ds_read_b128 v[236:239], v21 offset:57344
    v_mul_u32_u24 v30, 85599, v22
    v_lshrrev_b32 v30, 24, v30
    v_mul_u32_u24 v44, 196, v30
    v_sub_u32 v22, v22, v44
    v_lshlrev_b32 v22, 4, v22
    ds_read_b128 v[240:243], v22 offset:57344
    v_mul_u32_u24 v31, 85599, v23
    v_lshrrev_b32 v31, 24, v31
    v_mul_u32_u24 v44, 196, v31
    v_sub_u32 v23, v23, v44
    v_lshlrev_b32 v23, 4, v23
    ds_read_b128 v[244:247], v23 offset:57344
    s_waitcnt lgkmcnt(3)
    v_mad_u32_u24 v232, v28, v232, v233
    v_and_b32 v234, v232, v234
    v_add_lshl_u32 v232, v232, v234, 7
    v_lshrrev_b32 v233, 8, v232
    v_or_b32 v233, 3, v233
    v_and_or_b32 v232, v233, v235, v232
    v_lshl_or_b32 v20, v12, 24, v232
    s_waitcnt lgkmcnt(2)
    v_mad_u32_u24 v236, v29, v236, v237
    v_and_b32 v238, v236, v238
    v_add_lshl_u32 v236, v236, v238, 7
    v_lshrrev_b32 v237, 8, v236
    v_or_b32 v237, 3, v237
    v_and_or_b32 v236, v237, v239, v236
    v_lshl_or_b32 v21, v13, 24, v236
    s_waitcnt lgkmcnt(1)
    v_mad_u32_u24 v240, v30, v240, v241
    v_and_b32 v242, v240, v242
    v_add_lshl_u32 v240, v240, v242, 7
    v_lshrrev_b32 v241, 8, v240
    v_or_b32 v241, 3, v241
    v_and_or_b32 v240, v241, v243, v240
    v_lshl_or_b32 v22, v14, 24, v240
    s_waitcnt lgkmcnt(0)
    v_mad_u32_u24 v244, v31, v244, v245
    v_and_b32 v246, v244, v246
    v_add_lshl_u32 v244, v244, v246, 7
    v_lshrrev_b32 v245, 8, v244
    v_or_b32 v245, 3, v245
    v_and_or_b32 v244, v245, v247, v244
    v_lshl_or_b32 v23, v15, 24, v244
    s_waitcnt lgkmcnt(0)
    v_max3_u32 v28, v104, v105, v106
    v_max_u32 v28, v28, v107
    v_max3_u32 v29, v108, v109, v110
    v_max_u32 v29, v29, v111
    v_cndmask_b32 v29, 0, v29, s[88:89]
    v_max_u32 v28, v28, v29
    v_cmp_lt_u32 vcc, 30, v28
    s_cbranch_vccnz K_CELLOVF
    v_lshlrev_b32 v28, 7, v96
    v_lshl_add_u32 v28, v104, 2, v28
    ds_write_b32 v28, v16 offset:0
    v_lshlrev_b32 v28, 7, v97
    v_lshl_add_u32 v28, v105, 2, v28
    ds_write_b32 v28, v17 offset:0
    v_lshlrev_b32 v28, 7, v98
    v_lshl_add_u32 v28, v106, 2, v28
    ds_write_b32 v28, v18 offset:0
    v_lshlrev_b32 v28, 7, v99
    v_lshl_add_u32 v28, v107, 2, v28
    ds_write_b32 v28, v19 offset:0
    s_mov_b64 exec, s[88:89]
    v_lshlrev_b32 v28, 7, v100
    v_lshl_add_u32 v28, v108, 2, v28
    ds_write_b32 v28, v20 offset:0
    v_lshlrev_b32 v28, 7, v101
    v_lshl_add_u32 v28, v109, 2, v28
    ds_write_b32 v28, v21 offset:0
    v_lshlrev_b32 v28, 7, v102
    v_lshl_add_u32 v28, v110, 2, v28
    ds_write_b32 v28, v22 offset:0
    v_lshlrev_b32 v28, 7, v103
    v_lshl_add_u32 v28, v111, 2, v28
    ds_write_b32 v28, v23 offset:0
K_CELLDONE:
    s_mov_b64 exec, 1
    v_mov_b32 v28, 161704
    s_waitcnt lgkmcnt(0)
    ds_add_u32 v28, v50
K_SYNC2:
    ds_read_b32 v29, v28
    s_waitcnt lgkmcnt(0)
    v_readfirstlane_b32 s62, v29
    s_cmp_lt_u32 s62, 7
    s_cbranch_scc1 K_SYNC2
    s_mov_b64 exec, -1
    ds_read_b128 v[96:99], v27 offset:0
    ds_read_b128 v[100:103], v27 offset:7168
    ds_read_b128 v[104:107], v27 offset:14336
    ds_read_b128 v[108:111], v27 offset:21504
    v_cmp_gt_u32 vcc, 256, v0
    s_mov_b64 exec, vcc
    ds_read_b128 v[112:115], v27 offset:28672
    s_mov_b64 exec, -1
    v_add_u32 v29, 0, v26
    v_xor_b32 v28, s2, v29
    v_lshl_add_u32 v28, v29, 8, v28
    v_lshl_add_u32 v28, v28, 7, v2
    s_waitcnt lgkmcnt(4)
    buffer_store_dwordx4 v[96:99], v28, s[24:27], 0 offen sc1
    v_add_u32 v29, 56, v26
    v_xor_b32 v28, s2, v29
    v_lshl_add_u32 v28, v29, 8, v28
    v_lshl_add_u32 v28, v28, 7, v2
    s_waitcnt lgkmcnt(3)
    buffer_store_dwordx4 v[100:103], v28, s[24:27], 0 offen sc1
    v_add_u32 v29, 112, v26
    v_xor_b32 v28, s2, v29
    v_lshl_add_u32 v28, v29, 8, v28
    v_lshl_add_u32 v28, v28, 7, v2
    s_waitcnt lgkmcnt(2)
    buffer_store_dwordx4 v[104:107], v28, s[24:27], 0 offen sc1
    v_add_u32 v29, 168, v26
    v_xor_b32 v28, s2, v29
    v_lshl_add_u32 v28, v29, 8, v28
    v_lshl_add_u32 v28, v28, 7, v2
    s_waitcnt lgkmcnt(1)
    buffer_store_dwordx4 v[108:111], v28, s[24:27], 0 offen sc1
    v_add_u32 v29, 224, v26
    v_xor_b32 v28, s2, v29
    v_lshl_add_u32 v28, v29, 8, v28
    v_lshl_add_u32 v28, v28, 7, v2
    s_waitcnt lgkmcnt(0)
    buffer_store_dwordx4 v[112:115], v28, s[24:27], 0 offen sc1
    s_cmp_lg_u32 s3, 0
    s_cbranch_scc1 K_NOHDR
    s_mov_b64 exec, 1
    v_mov_b32 v28, 0
    ds_read_b32 v29, v28 offset:33792
    s_lshl_b32 s62, s2, 2
    s_add_u32 s62, s62, 528384
    s_mov_b32 s18, 529408
    s_waitcnt lgkmcnt(0)
    buffer_store_dword v29, v28, s[16:19], s62 offen sc1
    s_mov_b32 s18, 0x60000
    buffer_load_dword v44, v28, s[32:35], 0 offen sc1
    s_mov_b64 exec, -1
K_NOHDR:
    s_waitcnt vmcnt(0)
    s_cmp_lg_u32 s3, 0
    s_cbranch_scc1 K_ZW1
K_ZW:
    v_readfirstlane_b32 s62, v44
    s_cmp_ge_u32 s62, 16
    s_cbranch_scc1 K_ZW1
    v_mov_b32 v28, 0
    buffer_load_dword v44, v28, s[32:35], 0 offen sc1
    s_add_u32 s57, s57, 1
    s_cmp_gt_u32 s57, 16777216
    s_cbranch_scc1 K_END
    s_waitcnt vmcnt(0)
    s_branch K_ZW
K_ZW1:
    s_mov_b64 exec, 1
    v_mov_b32 v28, 161708
    ds_add_rtn_u32 v29, v28, v50
    s_waitcnt lgkmcnt(0)
    v_readfirstlane_b32 s62, v29
    s_cmp_eq_u32 s62, 6
    s_cbranch_scc0 K_NOARR
    s_and_b32 s62, s72, 0x1000
    s_lshl_b32 s62, s62, 1
    s_add_u32 s62, s62, s72
    s_add_u32 s62, s62, 0x40000
    s_mov_b64 exec, 0xff
    v_lshlrev_b32 v29, 14, v1
    buffer_atomic_add v50, v29, s[16:19], s62 offen sc1
K_NOARR:
    s_mov_b64 exec, -1
    v_add_u32 v28, 0, v26
    v_subrev_u32 v48, 80, v28
    v_cmp_gt_u32 vcc, 48, v28
    v_mul_u32_u24 v112, 116, v46
    v_subrev_u32 v49, 48, v28
    v_cndmask_b32 v48, v48, v28, vcc
    v_cmp_gt_u32 vcc, 80, v49
    v_add_u32 v48, 40960, v48
    v_add_u32 v48, v48, v112
    v_mul_u32_u24 v112, 80, v46
    v_add_u32 v112, v112, v49
    v_and_b32 v28, 0xffffffc0, v112
    v_add_u32 v112, v112, v28
    v_lshrrev_b32 v28, 8, v112
    v_and_or_b32 v112, v28, 64, v112
    v_cndmask_b32 v112, v48, v112, vcc
    v_lshlrev_b32 v112, 7, v112
    v_xor_b32 v113, 0x2000, v112
    v_cndmask_b32 v113, v36, v113, vcc
    v_add_u32 v112, v112, v2
    v_add_u32 v113, v113, v2
    v_add_u32 v28, 56, v26
    v_subrev_u32 v48, 80, v28
    v_cmp_gt_u32 vcc, 48, v28
    v_mul_u32_u24 v114, 116, v46
    v_subrev_u32 v49, 48, v28
    v_cndmask_b32 v48, v48, v28, vcc
    v_cmp_gt_u32 vcc, 80, v49
    v_add_u32 v48, 40960, v48
    v_add_u32 v48, v48, v114
    v_mul_u32_u24 v114, 80, v46
    v_add_u32 v114, v114, v49
    v_and_b32 v28, 0xffffffc0, v114
    v_add_u32 v114, v114, v28
    v_lshrrev_b32 v28, 8, v114
    v_and_or_b32 v114, v28, 64, v114
    v_cndmask_b32 v114, v48, v114, vcc
    v_lshlrev_b32 v114, 7, v114
    v_xor_b32 v115, 0x2000, v114
    v_cndmask_b32 v115, v36, v115, vcc
    v_add_u32 v114, v114, v2
    v_add_u32 v115, v115, v2
    v_add_u32 v28, 112, v26
    v_subrev_u32 v48, 80, v28
    v_cmp_gt_u32 vcc, 48, v28
    v_mul_u32_u24 v116, 116, v46
    v_subrev_u32 v49, 48, v28
    v_cndmask_b32 v48, v48, v28, vcc
    v_cmp_gt_u32 vcc, 80, v49
    v_add_u32 v48, 40960, v48
    v_add_u32 v48, v48, v116
    v_mul_u32_u24 v116, 80, v46
    v_add_u32 v116, v116, v49
    v_and_b32 v28, 0xffffffc0, v116
    v_add_u32 v116, v116, v28
    v_lshrrev_b32 v28, 8, v116
    v_and_or_b32 v116, v28, 64, v116
    v_cndmask_b32 v116, v48, v116, vcc
    v_lshlrev_b32 v116, 7, v116
    v_xor_b32 v117, 0x2000, v116
    v_cndmask_b32 v117, v36, v117, vcc
    v_add_u32 v116, v116, v2
    v_add_u32 v117, v117, v2
    v_add_u32 v28, 168, v26
    v_mov_b32 v51, v28
    v_subrev_u32 v48, 80, v28
    v_cmp_gt_u32 vcc, 48, v28
    v_mul_u32_u24 v118, 116, v46
    v_subrev_u32 v49, 48, v28
    v_cndmask_b32 v48, v48, v28, vcc
    v_cmp_gt_u32 vcc, 80, v49
    v_add_u32 v48, 40960, v48
    v_add_u32 v48, v48, v118
    v_mul_u32_u24 v118, 80, v46
    v_add_u32 v118, v118, v49
    v_and_b32 v28, 0xffffffc0, v118
    v_add_u32 v118, v118, v28
    v_lshrrev_b32 v28, 8, v118
    v_and_or_b32 v118, v28, 64, v118
    v_cndmask_b32 v118, v48, v118, vcc
    v_lshlrev_b32 v118, 7, v118
    v_xor_b32 v119, 0x2000, v118
    v_cndmask_b32 v119, v36, v119, vcc
    v_cmp_gt_u32 vcc, 196, v51
    s_nop 1
    v_cndmask_b32 v118, v36, v118, vcc
    v_cndmask_b32 v119, v36, v119, vcc
    v_add_u32 v118, v118, v2
    v_add_u32 v119, v119, v2
    v_and_b32 v52, 15, v1
    v_and_b32 v53, 1, v52
    v_mul_u32_u24 v53, 0xffff, v53
    v_add_u32 v53, 1, v53
    v_mul_u32_u24 v53, 0x3f80, v53
    v_lshrrev_b32 v52, 1, v52
    v_lshrrev_b32 v54, 2, v1
    v_and_b32 v54, 4, v54
    v_xor_b32 v52, v52, v54
    v_cmp_eq_u32 vcc, 0, v52
    s_nop 1
    v_cndmask_b32 v8, 0, v53, vcc
    v_cmp_eq_u32 vcc, 1, v52
    s_nop 1
    v_cndmask_b32 v9, 0, v53, vcc
    v_cmp_eq_u32 vcc, 2, v52
    s_nop 1
    v_cndmask_b32 v10, 0, v53, vcc
    v_cmp_eq_u32 vcc, 3, v52
    s_nop 1
    v_cndmask_b32 v11, 0, v53, vcc
    s_cmp_eq_u32 s2, 255
    s_cbranch_scc1 K_WEIGHTS
K_WBACK:
    s_barrier
    s_branch K_PASSB
K_CELLOVF:
    s_lshl_b32 s62, s2, 15
    v_mov_b32 v31, 0xfffffffe
    v_mov_b32 v45, 0
    s_mov_b64 exec, -1
    v_lshlrev_b32 v28, 7, v96
    v_cmp_lt_u32 vcc, 30, v104
    v_min_u32 v29, 31, v104
    v_lshl_add_u32 v28, v29, 2, v28
    v_cndmask_b32 v29, v16, v31, vcc
    ds_write_b32 v28, v29 offset:0
    s_mov_b64 exec, vcc
    ds_add_rtn_u32 v29, v45, v50 offset:33792
    v_mov_b32 v52, v16
    v_mov_b32 v53, v96
    s_waitcnt lgkmcnt(0)
    v_lshlrev_b32 v29, 3, v29
    buffer_store_dwordx2 v[52:53], v29, s[84:87], s62 offen sc1
    s_nop 1
    s_mov_b64 exec, -1
    v_lshlrev_b32 v28, 7, v97
    v_cmp_lt_u32 vcc, 30, v105
    v_min_u32 v29, 31, v105
    v_lshl_add_u32 v28, v29, 2, v28
    v_cndmask_b32 v29, v17, v31, vcc
    ds_write_b32 v28, v29 offset:0
    s_mov_b64 exec, vcc
    ds_add_rtn_u32 v29, v45, v50 offset:33792
    v_mov_b32 v52, v17
    v_mov_b32 v53, v97
    s_waitcnt lgkmcnt(0)
    v_lshlrev_b32 v29, 3, v29
    buffer_store_dwordx2 v[52:53], v29, s[84:87], s62 offen sc1
    s_nop 1
    s_mov_b64 exec, -1
    v_lshlrev_b32 v28, 7, v98
    v_cmp_lt_u32 vcc, 30, v106
    v_min_u32 v29, 31, v106
    v_lshl_add_u32 v28, v29, 2, v28
    v_cndmask_b32 v29, v18, v31, vcc
    ds_write_b32 v28, v29 offset:0
    s_mov_b64 exec, vcc
    ds_add_rtn_u32 v29, v45, v50 offset:33792
    v_mov_b32 v52, v18
    v_mov_b32 v53, v98
    s_waitcnt lgkmcnt(0)
    v_lshlrev_b32 v29, 3, v29
    buffer_store_dwordx2 v[52:53], v29, s[84:87], s62 offen sc1
    s_nop 1
    s_mov_b64 exec, -1
    v_lshlrev_b32 v28, 7, v99
    v_cmp_lt_u32 vcc, 30, v107
    v_min_u32 v29, 31, v107
    v_lshl_add_u32 v28, v29, 2, v28
    v_cndmask_b32 v29, v19, v31, vcc
    ds_write_b32 v28, v29 offset:0
    s_mov_b64 exec, vcc
    ds_add_rtn_u32 v29, v45, v50 offset:33792
    v_mov_b32 v52, v19
    v_mov_b32 v53, v99
    s_waitcnt lgkmcnt(0)
    v_lshlrev_b32 v29, 3, v29
    buffer_store_dwordx2 v[52:53], v29, s[84:87], s62 offen sc1
    s_nop 1
    s_mov_b64 exec, s[88:89]
    v_lshlrev_b32 v28, 7, v100
    v_cmp_lt_u32 vcc, 30, v108
    v_min_u32 v29, 31, v108
    v_lshl_add_u32 v28, v29, 2, v28
    v_cndmask_b32 v29, v20, v31, vcc
    ds_write_b32 v28, v29 offset:0
    s_mov_b64 exec, vcc
    ds_add_rtn_u32 v29, v45, v50 offset:33792
    v_mov_b32 v52, v20
    v_mov_b32 v53, v100
    s_waitcnt lgkmcnt(0)
    v_lshlrev_b32 v29, 3, v29
    buffer_store_dwordx2 v[52:53], v29, s[84:87], s62 offen sc1
    s_nop 1
    s_mov_b64 exec, s[88:89]
    v_lshlrev_b32 v28, 7, v101
    v_cmp_lt_u32 vcc, 30, v109
    v_min_u32 v29, 31, v109
    v_lshl_add_u32 v28, v29, 2, v28
    v_cndmask_b32 v29, v21, v31, vcc
    ds_write_b32 v28, v29 offset:0
    s_mov_b64 exec, vcc
    ds_add_rtn_u32 v29, v45, v50 offset:33792
    v_mov_b32 v52, v21
    v_mov_b32 v53, v101
    s_waitcnt lgkmcnt(0)
    v_lshlrev_b32 v29, 3, v29
    buffer_store_dwordx2 v[52:53], v29, s[84:87], s62 offen sc1
    s_nop 1
    s_mov_b64 exec, s[88:89]
    v_lshlrev_b32 v28, 7, v102
    v_cmp_lt_u32 vcc, 30, v110
    v_min_u32 v29, 31, v110
    v_lshl_add_u32 v28, v29, 2, v28
    v_cndmask_b32 v29, v22, v31, vcc
    ds_write_b32 v28, v29 offset:0
    s_mov_b64 exec, vcc
    ds_add_rtn_u32 v29, v45, v50 offset:33792
    v_mov_b32 v52, v22
    v_mov_b32 v53, v102
    s_waitcnt lgkmcnt(0)
    v_lshlrev_b32 v29, 3, v29
    buffer_store_dwordx2 v[52:53], v29, s[84:87], s62 offen sc1
    s_nop 1
    s_mov_b64 exec, s[88:89]
    v_lshlrev_b32 v28, 7, v103
    v_cmp_lt_u32 vcc, 30, v111
    v_min_u32 v29, 31, v111
    v_lshl_add_u32 v28, v29, 2, v28
    v_cndmask_b32 v29, v23, v31, vcc
    ds_write_b32 v28, v29 offset:0
    s_mov_b64 exec, vcc
    ds_add_rtn_u32 v29, v45, v50 offset:33792
    v_mov_b32 v52, v23
    v_mov_b32 v53, v103
    s_waitcnt lgkmcnt(0)
    v_lshlrev_b32 v29, 3, v29
    buffer_store_dwordx2 v[52:53], v29, s[84:87], s62 offen sc1
    s_nop 1
    s_branch K_CELLDONE
K_PROBE:
    s_add_u32 s80, s6, 0x7000000
    s_addc_u32 s81, s7, 0
    s_mov_b32 s82, 0x100000
    s_lshr_b32 s62, s2, 4
    s_lshl_b32 s62, s62, 14
    s_and_b32 s63, s2, 15
    s_lshl_b32 s63, s63, 9
    s_add_u32 s62, s62, s63
    v_and_b32 v28, 3, v1
    v_lshlrev_b32 v28, 7, v28
    v_and_b32 v29, 4, v1
    v_lshl_add_u32 v28, v29, 11, v28
    v_bfe_u32 v29, v1, 3, 3
    v_lshl_add_u32 v28, v29, 4, v28
    buffer_store_dwordx4 v[32:35], v28, s[80:83], s62 offen sc1
    s_cmp_ge_u32 s2, 16
    s_cbranch_scc1 K_NOZERO
    s_waitcnt vmcnt(4)
    s_mov_b64 exec, 1
    buffer_atomic_add v50, v32, s[32:35], 0 offen sc1
    s_mov_b64 exec, -1
K_NOZERO:
    v_mov_b32 v28, 161704
K_PW:
    ds_read_b32 v29, v28
    s_sleep 1
    s_add_u32 s57, s57, 1
    s_cmp_gt_u32 s57, 16777216
    s_cbranch_scc1 K_END
    s_waitcnt lgkmcnt(0)
    v_readfirstlane_b32 s64, v29
    s_cmp_lt_u32 s64, 7
    s_cbranch_scc1 K_PW
    v_mov_b32 v28, s62
    buffer_load_dword v30, v28, s[80:83], 0 offen offset:384 sc1
    s_mov_b32 s90, -1
    s_mov_b32 s91, -1
    s_waitcnt vmcnt(0)
    v_add_u32 v29, 0, v28
    s_memtime s[64:65]
    s_waitcnt lgkmcnt(0)
    buffer_load_dword v30, v29, s[80:83], 0 offen sc1
    s_waitcnt vmcnt(0)
    s_memtime s[66:67]
    s_waitcnt lgkmcnt(0)
    s_sub_u32 s66, s66, s64
    s_min_u32 s90, s90, s66
    v_add_u32 v29, 8192, v28
    s_memtime s[64:65]
    s_waitcnt lgkmcnt(0)
    buffer_load_dword v30, v29, s[80:83], 0 offen sc1
    s_waitcnt vmcnt(0)
    s_memtime s[66:67]
    s_waitcnt lgkmcnt(0)
    s_sub_u32 s66, s66, s64
    s_min_u32 s91, s91, s66
    v_add_u32 v29, 128, v28
    s_memtime s[64:65]
    s_waitcnt lgkmcnt(0)
    buffer_load_dword v30, v29, s[80:83], 0 offen sc1
    s_waitcnt vmcnt(0)
    s_memtime s[66:67]
    s_waitcnt lgkmcnt(0)
    s_sub_u32 s66, s66, s64
    s_min_u32 s90, s90, s66
    v_add_u32 v29, 8320, v28
    s_memtime s[64:65]
    s_waitcnt lgkmcnt(0)
    buffer_load_dword v30, v29, s[80:83], 0 offen sc1
    s_waitcnt vmcnt(0)
    s_memtime s[66:67]
    s_waitcnt lgkmcnt(0)
    s_sub_u32 s66, s66, s64
    s_min_u32 s91, s91, s66
    s_getreg_b32 s64, hwreg(HW_REG_XCC_ID)
    s_lshr_b32 s64, s64, 2
    s_cmp_gt_u32 s90, s91
    s_cselect_b32 s66, 1, 0
    s_xor_b32 s66, s66, s64
    s_and_b32 s66, s66, 1
    s_add_u32 s66, s66, 1
    s_add_u32 s80, s6, 0x7180000
    s_addc_u32 s81, s7, 0
    s_mov_b32 s82, 0x400
    s_mov_b32 s83, 0x20000
    s_mov_b64 exec, 1
    v_mov_b32 v28, s66
    v_mov_b32 v29, 0
    s_lshl_b32 s62, s2, 2
    buffer_store_dword v28, v29, s[80:83], s62 offen sc1
    s_mov_b64 exec, -1
    s_getreg_b32 s62, hwreg(HW_REG_XCC_ID)
    s_and_b32 s62, s62, 7
    s_lshl_b32 s62, s62, 14
    v_and_b32 v30, 32, v1
    v_lshlrev_b32 v30, 8, v30
    v_lshl_add_u32 v30, v1, 7, v30
    v_add_u32 v45, s62, v30
    s_cmp_eq_u32 s2, 255
    s_cbranch_scc1 K_WEIGHTS
    v_mov_b32 v28, 161708
K_OWN:
    ds_read_b32 v29, v28
    s_sleep 1
    s_add_u32 s57, s57, 1
    s_cmp_gt_u32 s57, 16777216
    s_cbranch_scc1 K_END
    s_waitcnt lgkmcnt(0)
    v_readfirstlane_b32 s62, v29
    s_cmp_lt_u32 s62, 7
    s_cbranch_scc1 K_OWN
K_GO:
    s_mov_b32 s63, 0x40000
    buffer_load_dword v28, v45, s[16:19], s63 offen sc1
    s_add_u32 s57, s57, 1
    s_cmp_gt_u32 s57, 16777216
    s_cbranch_scc1 K_END
    s_waitcnt vmcnt(0)
    v_cmp_le_u32 vcc, 4, v28
    s_cmp_eq_u64 vcc, -1
    s_cbranch_scc1 K_GONE
    s_sleep 4
    s_branch K_GO
K_GONE:
    s_mov_b64 exec, -1
    s_barrier
K_PASSB:
    s_add_u32 s80, s6, 0x7180000
    s_addc_u32 s81, s7, 0
    s_mov_b32 s82, 0x400
    s_mov_b32 s83, 0x20000
    s_lshl_b32 s62, s2, 15
    v_lshrrev_b32 v24, 1, v0
    v_lshlrev_b32 v25, 7, v24
    v_and_b32 v44, 1, v0
    v_lshl_add_u32 v25, v44, 4, v25
    v_xor_b32 v24, s2, v24
    buffer_load_dwordx4 v[96:99], v25, s[24:27], s62 offen offset:0 sc1
    buffer_load_dwordx4 v[100:103], v25, s[24:27], s62 offen offset:32 sc1
    buffer_load_dwordx4 v[104:107], v25, s[24:27], s62 offen offset:64 sc1
    buffer_load_dwordx4 v[108:111], v25, s[24:27], s62 offen offset:96 sc1
    v_lshlrev_b32 v28, 4, v1
    buffer_load_dwordx4 v[40:43], v28, s[80:83], 0 offen sc1
    s_cmp_eq_u32 s3, 7
    s_cbranch_scc1 K_NOG0
    s_cmp_eq_u32 s2, 255
    s_cbranch_scc1 K_NOG0
    s_waitcnt vmcnt(5)
    v_lshlrev_b32 v49, 16, v80
    v_lshlrev_b32 v52, 16, v64
    v_and_b32 v53, 0xffff0000, v64
    v_lshlrev_b32 v54, 16, v65
    v_and_b32 v55, 0xffff0000, v65
    v_lshlrev_b32 v56, 16, v66
    v_and_b32 v57, 0xffff0000, v66
    v_lshlrev_b32 v58, 16, v67
    v_and_b32 v59, 0xffff0000, v67
    v_mul_f32 v52, v49, v52
    v_mul_f32 v53, v49, v53
    v_mul_f32 v54, v49, v54
    v_mul_f32 v55, v49, v55
    v_mul_f32 v56, v49, v56
    v_mul_f32 v57, v49, v57
    v_mul_f32 v58, v49, v58
    v_mul_f32 v59, v49, v59
    v_cvt_pk_bf16_f32 v64, v52, v53
    v_cvt_pk_bf16_f32 v65, v54, v55
    v_cvt_pk_bf16_f32 v66, v56, v57
    v_cvt_pk_bf16_f32 v67, v58, v59
    buffer_store_dwordx4 v[64:67], v112, s[12:15], 0 offen sc1
    buffer_store_dwordx4 v[64:67], v113, s[12:15], 0 offen sc1
    v_lshlrev_b32 v49, 16, v81
    v_lshlrev_b32 v52, 16, v68
    v_and_b32 v53, 0xffff0000, v68
    v_lshlrev_b32 v54, 16, v69
    v_and_b32 v55, 0xffff0000, v69
    v_lshlrev_b32 v56, 16, v70
    v_and_b32 v57, 0xffff0000, v70
    v_lshlrev_b32 v58, 16, v71
    v_and_b32 v59, 0xffff0000, v71
    v_mul_f32 v52, v49, v52
    v_mul_f32 v53, v49, v53
    v_mul_f32 v54, v49, v54
    v_mul_f32 v55, v49, v55
    v_mul_f32 v56, v49, v56
    v_mul_f32 v57, v49, v57
    v_mul_f32 v58, v49, v58
    v_mul_f32 v59, v49, v59
    v_cvt_pk_bf16_f32 v68, v52, v53
    v_cvt_pk_bf16_f32 v69, v54, v55
    v_cvt_pk_bf16_f32 v70, v56, v57
    v_cvt_pk_bf16_f32 v71, v58, v59
    buffer_store_dwordx4 v[68:71], v114, s[12:15], 0 offen sc1
    buffer_store_dwordx4 v[68:71], v115, s[12:15], 0 offen sc1
    v_lshlrev_b32 v49, 16, v82
    v_lshlrev_b32 v52, 16, v72
    v_and_b32 v53, 0xffff0000, v72
    v_lshlrev_b32 v54, 16, v73
    v_and_b32 v55, 0xffff0000, v73
    v_lshlrev_b32 v56, 16, v74
    v_and_b32 v57, 0xffff0000, v74
    v_lshlrev_b32 v58, 16, v75
    v_and_b32 v59, 0xffff0000, v75
    v_mul_f32 v52, v49, v52
    v_mul_f32 v53, v49, v53
    v_mul_f32 v54, v49, v54
    v_mul_f32 v55, v49, v55
    v_mul_f32 v56, v49, v56
    v_mul_f32 v57, v49, v57
    v_mul_f32 v58, v49, v58
    v_mul_f32 v59, v49, v59
    v_cvt_pk_bf16_f32 v72, v52, v53
    v_cvt_pk_bf16_f32 v73, v54, v55
    v_cvt_pk_bf16_f32 v74, v56, v57
    v_cvt_pk_bf16_f32 v75, v58, v59
    buffer_store_dwordx4 v[72:75], v116, s[12:15], 0 offen sc1
    buffer_store_dwordx4 v[72:75], v117, s[12:15], 0 offen sc1
    v_lshlrev_b32 v49, 16, v83
    v_lshlrev_b32 v52, 16, v76
    v_and_b32 v53, 0xffff0000, v76
    v_lshlrev_b32 v54, 16, v77
    v_and_b32 v55, 0xffff0000, v77
    v_lshlrev_b32 v56, 16, v78
    v_and_b32 v57, 0xffff0000, v78
    v_lshlrev_b32 v58, 16, v79
    v_and_b32 v59, 0xffff0000, v79
    v_mul_f32 v52, v49, v52
    v_mul_f32 v53, v49, v53
    v_mul_f32 v54, v49, v54
    v_mul_f32 v55, v49, v55
    v_mul_f32 v56, v49, v56
    v_mul_f32 v57, v49, v57
    v_mul_f32 v58, v49, v58
    v_mul_f32 v59, v49, v59
    v_cvt_pk_bf16_f32 v76, v52, v53
    v_cvt_pk_bf16_f32 v77, v54, v55
    v_cvt_pk_bf16_f32 v78, v56, v57
    v_cvt_pk_bf16_f32 v79, v58, v59
    buffer_store_dwordx4 v[76:79], v118, s[12:15], 0 offen sc1
    buffer_store_dwordx4 v[76:79], v119, s[12:15], 0 offen sc1
    s_waitcnt vmcnt(8)
    s_branch K_G0DONE
K_NOG0:
    s_waitcnt vmcnt(0)
K_G0DONE:
    s_add_u32 s12, s12, 0x1000000
    s_addc_u32 s13, s13, 0
    s_mov_b32 s68, 0xc4000000
    v_mov_b32 v112, 0
    v_mov_b32 v113, 0
    v_mov_b32 v114, 0
    v_mov_b32 v115, 0
    v_mov_b32 v116, 0
    v_mov_b32 v117, 0
    v_mov_b32 v118, 0
    v_mov_b32 v119, 0
    v_cmp_gt_u32 vcc, s68, v96
    s_cbranch_vccz K_CNT_DONE
    s_mov_b64 exec, vcc
    v_alignbit_b32 v52, v96, v96, 22
    v_and_b32 v52, 0x7fc, v52
    ds_add_rtn_u32 v112, v52, v50 offset:34816
    v_cmp_gt_u32 vcc, s68, v97
    s_cbranch_vccz K_CNT_DONE
    s_mov_b64 exec, vcc
    v_alignbit_b32 v52, v97, v97, 22
    v_and_b32 v52, 0x7fc, v52
    ds_add_rtn_u32 v113, v52, v50 offset:34816
    v_cmp_gt_u32 vcc, s68, v98
    s_cbranch_vccz K_CNT_DONE
    s_mov_b64 exec, vcc
    v_alignbit_b32 v52, v98, v98, 22
    v_and_b32 v52, 0x7fc, v52
    ds_add_rtn_u32 v114, v52, v50 offset:34816
    v_cmp_gt_u32 vcc, s68, v99
    s_cbranch_vccz K_CNT_DONE
    s_mov_b64 exec, vcc
    v_alignbit_b32 v52, v99, v99, 22
    v_and_b32 v52, 0x7fc, v52
    ds_add_rtn_u32 v115, v52, v50 offset:34816
    v_cmp_gt_u32 vcc, s68, v100
    s_cbranch_vccz K_CNT_DONE
    s_mov_b64 exec, vcc
    v_alignbit_b32 v52, v100, v100, 22
    v_and_b32 v52, 0x7fc, v52
    ds_add_rtn_u32 v116, v52, v50 offset:34816
    v_cmp_gt_u32 vcc, s68, v101
    s_cbranch_vccz K_CNT_DONE
    s_mov_b64 exec, vcc
    v_alignbit_b32 v52, v101, v101, 22
    v_and_b32 v52, 0x7fc, v52
    ds_add_rtn_u32 v117, v52, v50 offset:34816
    v_cmp_gt_u32 vcc, s68, v102
    s_cbranch_vccz K_CNT_DONE
    s_mov_b64 exec, vcc
    v_alignbit_b32 v52, v102, v102, 22
    v_and_b32 v52, 0x7fc, v52
    ds_add_rtn_u32 v118, v52, v50 offset:34816
    v_cmp_gt_u32 vcc, s68, v103
    s_cbranch_vccz K_CNT_DONE
    s_mov_b64 exec, vcc
    v_alignbit_b32 v52, v103, v103, 22
    v_and_b32 v52, 0x7fc, v52
    ds_add_rtn_u32 v119, v52, v50 offset:34816
    v_cmp_gt_u32 vcc, s68, v104
    s_cbranch_vccz K_CNT_DONE
    s_mov_b64 exec, vcc
    v_alignbit_b32 v52, v104, v104, 22
    v_and_b32 v52, 0x7fc, v52
    ds_add_rtn_u32 v120, v52, v50 offset:34816
    v_cmp_gt_u32 vcc, s68, v105
    s_cbranch_vccz K_CNT_DONE
    s_mov_b64 exec, vcc
    v_alignbit_b32 v52, v105, v105, 22
    v_and_b32 v52, 0x7fc, v52
    ds_add_rtn_u32 v121, v52, v50 offset:34816
    v_cmp_gt_u32 vcc, s68, v106
    s_cbranch_vccz K_CNT_DONE
    s_mov_b64 exec, vcc
    v_alignbit_b32 v52, v106, v106, 22
    v_and_b32 v52, 0x7fc, v52
    ds_add_rtn_u32 v122, v52, v50 offset:34816
    v_cmp_gt_u32 vcc, s68, v107
    s_cbranch_vccz K_CNT_DONE
    s_mov_b64 exec, vcc
    v_alignbit_b32 v52, v107, v107, 22
    v_and_b32 v52, 0x7fc, v52
    ds_add_rtn_u32 v123, v52, v50 offset:34816
    v_cmp_gt_u32 vcc, s68, v108
    s_cbranch_vccz K_CNT_DONE
    s_mov_b64 exec, vcc
    v_alignbit_b32 v52, v108, v108, 22
    v_and_b32 v52, 0x7fc, v52
    ds_add_rtn_u32 v124, v52, v50 offset:34816
    v_cmp_gt_u32 vcc, s68, v109
    s_cbranch_vccz K_CNT_DONE
    s_mov_b64 exec, vcc
    v_alignbit_b32 v52, v109, v109, 22
    v_and_b32 v52, 0x7fc, v52
    ds_add_rtn_u32 v125, v52, v50 offset:34816
    v_cmp_gt_u32 vcc, s68, v110
    s_cbranch_vccz K_CNT_DONE
    s_mov_b64 exec, vcc
    v_alignbit_b32 v52, v110, v110, 22
    v_and_b32 v52, 0x7fc, v52
    ds_add_rtn_u32 v126, v52, v50 offset:34816
    v_cmp_gt_u32 vcc, s68, v111
    s_cbranch_vccz K_CNT_DONE
    s_mov_b64 exec, vcc
    v_alignbit_b32 v52, v111, v111, 22
    v_and_b32 v52, 0x7fc, v52
    ds_add_rtn_u32 v127, v52, v50 offset:34816
K_CNT_DONE:
    s_mov_b64 exec, -1
    v_cmp_eq_u32 vcc, 0xfffffffe, v111
    s_cbranch_vccz K_OC_X
    v_lshlrev_b32 v54, 2, v24
    v_cndmask_b32 v54, v36, v54, vcc
    s_mov_b32 s62, 528384
    s_mov_b32 s18, 529408
    buffer_load_dword v55, v54, s[16:19], s62 offen sc1
    s_mov_b32 s18, 0x60000
    v_lshlrev_b32 v54, 15, v24
    s_waitcnt vmcnt(0)
K_OC_L:
    v_cmp_lt_i32 vcc, 0, v55
    s_cbranch_vccz K_OC_X
    s_mov_b64 exec, vcc
    buffer_load_dwordx2 v[56:57], v54, s[84:87], 0 offen sc1
    v_add_u32 v54, 8, v54
    v_subrev_u32 v55, 1, v55
    s_waitcnt vmcnt(0)
    v_cmp_eq_u32 vcc, v57, v46
    s_mov_b64 exec, vcc
    v_alignbit_b32 v52, v56, v56, 22
    v_and_b32 v52, 0x7fc, v52
    ds_add_u32 v52, v50 offset:36864
    s_mov_b64 exec, -1
    s_branch K_OC_L
K_OC_X:
    s_mov_b64 exec, -1
    s_mov_b32 s64, 0
    v_cmp_eq_u32 vcc, 2, v40
    s_bcnt1_i32_b64 s62, vcc
    s_add_u32 s64, s64, s62
    v_cmp_eq_u32 vcc, 1, v40
    s_bcnt1_i32_b64 s62, vcc
    s_sub_u32 s64, s64, s62
    v_cmp_eq_u32 vcc, 2, v41
    s_bcnt1_i32_b64 s62, vcc
    s_add_u32 s64, s64, s62
    v_cmp_eq_u32 vcc, 1, v41
    s_bcnt1_i32_b64 s62, vcc
    s_sub_u32 s64, s64, s62
    v_cmp_eq_u32 vcc, 2, v42
    s_bcnt1_i32_b64 s62, vcc
    s_add_u32 s64, s64, s62
    v_cmp_eq_u32 vcc, 1, v42
    s_bcnt1_i32_b64 s62, vcc
    s_sub_u32 s64, s64, s62
    v_cmp_eq_u32 vcc, 2, v43
    s_bcnt1_i32_b64 s62, vcc
    s_add_u32 s64, s64, s62
    v_cmp_eq_u32 vcc, 1, v43
    s_bcnt1_i32_b64 s62, vcc
    s_sub_u32 s64, s64, s62
    s_getreg_b32 s65, hwreg(HW_REG_XCC_ID)
    s_lshr_b32 s65, s65, 2
    s_cmp_gt_i32 s64, 0
    s_cselect_b32 s64, 1, 0
    s_xor_b32 s64, s64, s65
    s_and_b32 s64, s64, 1
    s_lshl_b32 s75, s64, 13
    v_lshlrev_b32 v52, 13, v1
    s_lshr_b32 s65, s2, 4
    s_lshl_b32 s65, s65, 7
    v_add_u32 v23, s65, v52
    s_getreg_b32 s65, hwreg(HW_REG_XCC_ID)
    s_and_b32 s65, s65, 7
    s_lshl_b32 s65, s65, 14
    s_add_u32 s65, s65, s75
    v_and_b32 v7, 15, v1
    v_lshlrev_b32 v7, 7, v7
    v_add_u32 v7, s65, v7
    v_lshlrev_b32 v52, 2, v0
    s_waitcnt vmcnt(0) lgkmcnt(0)
    s_barrier
    s_cmp_lg_u32 s3, 7
    s_cbranch_scc1 K_NOPUB0
    s_cmp_eq_u32 s2, 255
    s_cbranch_scc1 K_NOPUB0
    s_mov_b32 exec_hi, 0
    buffer_atomic_add v50, v23, s[16:19], 0 offen sc1
    s_mov_b64 exec, -1
K_NOPUB0:
    s_cmp_ge_u32 s3, 4
    s_cbranch_scc1 K_NODE_SKIP1
    ds_read_b32 v56, v52 offset:34816
    ds_read_b32 v57, v52 offset:35840
    ds_read_b32 v58, v52 offset:36864
    ds_read_b32 v59, v52 offset:37888
    s_waitcnt lgkmcnt(0)
    v_add_u32 v56, v56, v58
    v_add_u32 v57, v57, v59
    v_cmp_lt_u32 vcc, 59, v56
    s_nop 1
    v_cndmask_b32 v60, 8, 8, vcc
    v_cndmask_b32 v61, 64, 0, vcc
    v_min_u32 v58, v60, v56
    v_add_u32 v59, v56, v57
    v_sub_u32 v59, v59, v58
    v_min_u32 v53, 63, v59
    v_sub_u32 v61, v61, v53
    v_cmp_gt_u32 vcc, 88, v0
    s_nop 1
    v_cndmask_b32 v53, v50, 0, vcc
    v_lshl_add_u32 v61, v53, 7, v61
    v_add_lshl_u32 v61, v61, 63, 2
    v_cmp_gt_u32 vcc, 196, v0
    s_mov_b64 exec, vcc
    ds_add_rtn_u32 v92, v61, v50 offset:40960
    s_mov_b64 exec, -1
K_NODE_SKIP1:
    s_waitcnt lgkmcnt(0)
    s_barrier
    s_cmp_ge_u32 s3, 4
    s_cbranch_scc1 K_NODE_SKIP2
    v_lshlrev_b32 v53, 4, v1
    ds_read_b128 v[64:67], v53 offset:40960
    v_add_u32 v53, s76, v53
    v_add_u32 v61, s76, v61
    v_mov_b32 v27, v0
    s_waitcnt lgkmcnt(0)
    v_add_u32 v69, v64, v65
    v_add_u32 v70, v69, v66
    v_add_u32 v71, v70, v67
    v_mov_b32 v68, v71
    s_nop 1
    v_add_u32_dpp v68, v68, v68 row_shr:1 row_mask:0xf bank_mask:0xf
    s_nop 1
    v_add_u32_dpp v68, v68, v68 row_shr:2 row_mask:0xf bank_mask:0xf
    s_nop 1
    v_add_u32_dpp v68, v68, v68 row_shr:4 row_mask:0xf bank_mask:0xf
    s_nop 1
    v_add_u32_dpp v68, v68, v68 row_shr:8 row_mask:0xf bank_mask:0xf
    s_nop 1
    v_add_u32_dpp v68, v68, v68 row_bcast:15 row_mask:0xa bank_mask:0xf
    s_nop 1
    v_add_u32_dpp v68, v68, v68 row_bcast:31 row_mask:0xc bank_mask:0xf
    v_sub_u32 v68, v68, v71
    v_add_u32 v71, v68, v70
    v_add_u32 v70, v68, v69
    v_add_u32 v69, v68, v64
    ds_write_b128 v53, v[68:71] offset:43008
    ds_read_b32 v93, v61 offset:43008
    v_subrev_u32 v48, 80, v27
    v_cmp_gt_u32 vcc, 48, v27
    v_mul_u32_u24 v72, 116, v46
    v_subrev_u32 v49, 48, v27
    v_cndmask_b32 v48, v48, v27, vcc
    v_cmp_gt_u32 vcc, 80, v49
    v_add_u32 v48, 40960, v48
    v_add_u32 v48, v48, v72
    v_mul_u32_u24 v72, 80, v46
    v_add_u32 v72, v72, v49
    v_and_b32 v27, 0xffffffc0, v72
    v_add_u32 v72, v72, v27
    v_lshrrev_b32 v27, 8, v72
    v_and_or_b32 v72, v27, 64, v72
    v_cndmask_b32 v72, v48, v72, vcc
    v_lshlrev_b32 v72, 7, v72
    v_xor_b32 v73, 0x2000, v72
    v_cndmask_b32 v73, v36, v73, vcc
    v_lshlrev_b32 v74, 16, v84
    v_add_u32 v75, s56, v0
    s_mov_b32 s62, 50000
    v_cmp_gt_u32 s[90:91], s62, v75
    v_cmp_gt_u32 vcc, 196, v0
    s_and_b64 s[90:91], vcc, s[90:91]
    v_lshlrev_b32 v75, 7, v75
    s_waitcnt lgkmcnt(0)
    v_add_u32 v92, v92, v93
    v_cndmask_b32 v92, v0, v92, vcc
    v_lshrrev_b32 v93, 1, v92
    v_and_b32 v93, 0x7c, v93
    v_and_b32 v92, 7, v92
    v_cndmask_b32 v72, v36, v72, s[90:91]
    v_cndmask_b32 v73, v36, v73, s[90:91]
    v_cndmask_b32 v74, 0, v74, s[90:91]
    v_cndmask_b32 v75, v36, v75, s[90:91]
    v_lshrrev_b32 v60, 1, v60
    v_add_u32 v53, 1, v59
    v_lshrrev_b32 v53, 1, v53
    v_max_u32 v53, 1, v53
    v_cmp_gt_u32 vcc, 200, v0
    v_add_u32 v52, 161728, v93
    s_mov_b64 exec, vcc
    ds_max_u32 v52, v60
    ds_max_u32 v52, v53 offset:128
    s_mov_b64 exec, -1
K_NODE_SKIP2:
    v_and_b32 v78, 31, v1
    v_lshlrev_b32 v78, 2, v78
    v_add_u32 v78, 161728, v78
    v_and_b32 v81, 7, v1
    v_lshlrev_b32 v82, 2, v81
    v_sub_u32 v83, 52, v82
    v_cmp_lt_u32 s[92:93], 2, v81
    v_cmp_gt_u32 s[94:95], 7, v1
    s_waitcnt lgkmcnt(0)
    s_barrier
    ds_read2_b32 v[76:77], v78 offset0:0 offset1:32
    s_waitcnt lgkmcnt(0)
    v_min_u32 v64, 0xfff, v77
    v_mul_u32_u24 v64, 32, v64
    v_mad_u32_u24 v64, v76, 24, v64
    v_add_u32 v64, 24, v64
    ds_bpermute_b32 v65, v82, v64
    ds_bpermute_b32 v66, v83, v64
    v_cmp_eq_u32 vcc, 7, v81
    s_nop 1
    v_cndmask_b32 v69, v81, -1, vcc
    s_waitcnt lgkmcnt(0)
    v_cndmask_b32 v66, 0, v66, s[92:93]
    v_cndmask_b32 v54, 0, 1, s[92:93]
    v_add_u32 v65, v65, v66
    v_lshl_add_u32 v65, v54, 24, v65
    v_or_b32 v66, v65, v69
    v_mov_b32 v70, 0
    s_nop 0
    v_sub_co_u32_dpp v55, vcc, v66, v66 row_ror:1 row_mask:0xf bank_mask:0xf
    s_nop 1
    v_addc_co_u32 v70, vcc, 0, v70, vcc
    v_sub_co_u32_dpp v55, vcc, v66, v66 row_ror:2 row_mask:0xf bank_mask:0xf
    s_nop 1
    v_addc_co_u32 v70, vcc, 0, v70, vcc
    v_sub_co_u32_dpp v55, vcc, v66, v66 row_ror:3 row_mask:0xf bank_mask:0xf
    s_nop 1
    v_addc_co_u32 v70, vcc, 0, v70, vcc
    v_sub_co_u32_dpp v55, vcc, v66, v66 row_ror:4 row_mask:0xf bank_mask:0xf
    s_nop 1
    v_addc_co_u32 v70, vcc, 0, v70, vcc
    v_sub_co_u32_dpp v55, vcc, v66, v66 row_ror:5 row_mask:0xf bank_mask:0xf
    s_nop 1
    v_addc_co_u32 v70, vcc, 0, v70, vcc
    v_sub_co_u32_dpp v55, vcc, v66, v66 row_ror:6 row_mask:0xf bank_mask:0xf
    s_nop 1
    v_addc_co_u32 v70, vcc, 0, v70, vcc
    v_sub_co_u32_dpp v55, vcc, v66, v66 row_ror:7 row_mask:0xf bank_mask:0xf
    s_nop 1
    v_addc_co_u32 v70, vcc, 0, v70, vcc
    v_mad_u32_u24 v70, v54, 3, v70
    v_add_lshl_u32 v70, v70, 11, 2
    ds_bpermute_b32 v66, v70, v64
    v_lshl_add_u32 v79, v81, 3, 2
    v_cndmask_b32 v70, -4, v70, s[94:95]
    ds_permute_b32 v80, v70, v79
    s_waitcnt lgkmcnt(1)
    v_add_u32 v65, v65, v66
    v_or_b32 v66, v65, v69
    v_mov_b32 v71, 0
    s_nop 0
    v_sub_co_u32_dpp v55, vcc, v66, v66 row_ror:1 row_mask:0xf bank_mask:0xf
    s_nop 1
    v_addc_co_u32 v71, vcc, 0, v71, vcc
    v_sub_co_u32_dpp v55, vcc, v66, v66 row_ror:2 row_mask:0xf bank_mask:0xf
    s_nop 1
    v_addc_co_u32 v71, vcc, 0, v71, vcc
    v_sub_co_u32_dpp v55, vcc, v66, v66 row_ror:3 row_mask:0xf bank_mask:0xf
    s_nop 1
    v_addc_co_u32 v71, vcc, 0, v71, vcc
    v_sub_co_u32_dpp v55, vcc, v66, v66 row_ror:4 row_mask:0xf bank_mask:0xf
    s_nop 1
    v_addc_co_u32 v71, vcc, 0, v71, vcc
    v_sub_co_u32_dpp v55, vcc, v66, v66 row_ror:5 row_mask:0xf bank_mask:0xf
    s_nop 1
    v_addc_co_u32 v71, vcc, 0, v71, vcc
    v_sub_co_u32_dpp v55, vcc, v66, v66 row_ror:6 row_mask:0xf bank_mask:0xf
    s_nop 1
    v_addc_co_u32 v71, vcc, 0, v71, vcc
    v_sub_co_u32_dpp v55, vcc, v66, v66 row_ror:7 row_mask:0xf bank_mask:0xf
    s_nop 1
    v_addc_co_u32 v71, vcc, 0, v71, vcc
    v_lshl_add_u32 v71, v54, 2, v71
    v_add_lshl_u32 v71, v71, 14, 2
    v_cndmask_b32 v71, -4, v71, s[94:95]
    v_add_u32 v79, 1, v79
    ds_permute_b32 v71, v71, v79
    s_waitcnt lgkmcnt(0)
    v_or3_b32 v85, v85, v80, v71
    v_cmp_gt_u32 vcc, 25, v1
    v_lshlrev_b32 v70, 2, v85
    s_nop 0
    v_cndmask_b32 v70, -4, v70, vcc
    v_cndmask_b32 v76, 0, v76, vcc
    v_cndmask_b32 v77, 0, v77, vcc
    v_add_u32 v71, 16, v70
    v_cndmask_b32 v71, -4, v71, vcc
    ds_permute_b32 v79, v70, v76
    ds_permute_b32 v80, v71, v77
    ds_bpermute_b32 v67, v93, v85
    s_waitcnt lgkmcnt(1)
    v_or_b32 v79, v79, v80
    v_mov_b32 v80, v79
    s_nop 1
    v_add_u32_dpp v80, v80, v80 row_shr:1 row_mask:0xf bank_mask:0xf
    s_nop 1
    v_add_u32_dpp v80, v80, v80 row_shr:2 row_mask:0xf bank_mask:0xf
    s_nop 1
    v_add_u32_dpp v80, v80, v80 row_shr:4 row_mask:0xf bank_mask:0xf
    s_nop 1
    v_add_u32_dpp v80, v80, v80 row_shr:8 row_mask:0xf bank_mask:0xf
    s_nop 1
    v_add_u32_dpp v80, v80, v80 row_bcast:15 row_mask:0xa bank_mask:0xf
    s_nop 1
    v_add_u32_dpp v80, v80, v80 row_bcast:31 row_mask:0xc bank_mask:0xf
    s_nop 0
    v_readlane_b32 s62, v80, 63
    s_mov_b32 s70, 0
    s_cmp_le_u32 s62, 292
    s_cbranch_scc1 K_NOCAP
    s_add_u32 s70, s70, 1
    v_min_u32 v79, 6, v79
    v_mov_b32 v80, v79
    s_nop 1
    v_add_u32_dpp v80, v80, v80 row_shr:1 row_mask:0xf bank_mask:0xf
    s_nop 1
    v_add_u32_dpp v80, v80, v80 row_shr:2 row_mask:0xf bank_mask:0xf
    s_nop 1
    v_add_u32_dpp v80, v80, v80 row_shr:4 row_mask:0xf bank_mask:0xf
    s_nop 1
    v_add_u32_dpp v80, v80, v80 row_shr:8 row_mask:0xf bank_mask:0xf
    s_nop 1
    v_add_u32_dpp v80, v80, v80 row_bcast:15 row_mask:0xa bank_mask:0xf
    s_nop 1
    v_add_u32_dpp v80, v80, v80 row_bcast:31 row_mask:0xc bank_mask:0xf
K_NOCAP:
    s_nop 1
    v_sub_u32 v80, v80, v79
    v_lshlrev_b32 v80, 6, v80
    v_add_u32 v80, 142720, v80
    s_waitcnt lgkmcnt(0)
    v_lshlrev_b32 v52, 2, v67
    v_add_u32 v53, 16, v52
    ds_bpermute_b32 v82, v52, v80
    ds_bpermute_b32 v83, v53, v80
    s_lshl_b32 s62, s3, 3
    v_readlane_b32 s71, v80, s62
    v_readlane_b32 s48, v79, s62
    s_add_u32 s62, s62, 1
    v_readlane_b32 s49, v79, s62
    s_add_u32 s62, s62, 1
    v_readlane_b32 s50, v79, s62
    s_add_u32 s62, s62, 1
    v_readlane_b32 s51, v79, s62
    s_add_u32 s62, s62, 1
    v_readlane_b32 s52, v79, s62
    s_add_u32 s62, s62, 1
    v_readlane_b32 s53, v79, s62
    s_add_u32 s62, s62, 1
    v_readlane_b32 s54, v79, s62
    s_add_u32 s62, s62, 1
    v_readlane_b32 s55, v79, s62
    s_cmp_ge_u32 s3, 4
    s_cbranch_scc1 K_NODE_SKIP3
    v_and_b32 v64, 3, v67
    v_lshrrev_b32 v65, 3, v67
    v_mul_u32_u24 v66, 7, v64
    v_add3_u32 v66, v66, v65, -7
    v_add_u32 v65, 18, v65
    v_cmp_eq_u32 vcc, 0, v64
    s_nop 1
    v_cndmask_b32 v66, v66, v65, vcc
    v_lshl_add_u32 v68, v66, 3, v92
    v_lshlrev_b32 v52, 4, v68
    v_add_u32 v52, 139520, v52
    v_cmp_gt_u32 vcc, 200, v0
    s_mov_b64 exec, vcc
    ds_write_b128 v52, v[72:75]
    s_mov_b64 exec, -1
    v_and_b32 v52, 3, v92
    v_lshlrev_b32 v52, 3, v52
    v_and_b32 v53, 4, v92
    v_add_u32 v52, v52, v53
    v_lshlrev_b32 v53, 4, v0
    v_sub_u32 v54, v56, v58
    s_waitcnt lgkmcnt(0)
    v_mov_b32 v64, v58
    v_add_u32 v65, v82, v52
    v_add_u32 v70, v83, v52
    v_mov_b32 v71, 41984
    v_cmp_gt_u32 vcc, 200, v0
    s_nop 1
    v_cndmask_b32 v70, v71, v70, vcc
    v_lshlrev_b32 v55, 5, v58
    v_sub_u32 v66, v70, v55
    v_add_u32 v67, 12, v58
    ds_write_b128 v53, v[64:67] offset:47104
    v_mov_b32 v76, 0
    v_lshl_add_u32 v78, v54, 5, v70
    v_sub_u32 v79, 12, v54
    ds_write_b128 v53, v[76:79] offset:51200
K_NODE_SKIP3:
    s_add_u32 s80, s6, 0x8400000
    s_addc_u32 s81, s7, 0
    s_mov_b32 s82, 0x30d400
    s_mov_b32 s83, 0x20000
    s_cmp_eq_u32 s70, 0
    s_cbranch_scc1 K_NOOVF1
    s_cmp_ge_u32 s3, 4
    s_cbranch_scc1 K_NOOVF1
    v_cmp_gt_u32 vcc, 200, v0
    s_mov_b64 exec, vcc
    v_max_u32 v55, 12, v59
    v_subrev_u32 v55, 12, v55
    v_mov_b32 v54, v55
    v_mov_b32 v52, 64
    buffer_atomic_add v54, v52, s[32:35], 0 offen sc0 sc1
    v_lshlrev_b32 v53, 2, v0
    v_lshlrev_b32 v52, 3, v68
    v_add_u32 v52, 162112, v52
    s_waitcnt vmcnt(0)
    v_lshlrev_b32 v54, 2, v54
    ds_write_b32 v53, v54 offset:55296
    ds_write_b64 v52, v[54:55]
    s_mov_b64 exec, -1
K_NOOVF1:
    s_mov_b32 s67, 0xffff80
    v_mov_b32 v51, s75
    s_waitcnt lgkmcnt(0)
    s_barrier
    ds_read_b32 v88, v4 offset:2316
    ds_read_b32 v89, v4 offset:12
    ds_read_b32 v90, v4 offset:908
    ds_read_b32 v91, v4 offset:1804
    s_waitcnt lgkmcnt(0)
    v_add_u32 v88, v88, v2
    buffer_load_dwordx4 v[160:163], v88, s[20:23], 0 offen
    v_add_u32 v89, v89, v2
    buffer_load_dwordx4 v[164:167], v89, s[20:23], 0 offen
    v_add_u32 v90, v90, v2
    buffer_load_dwordx4 v[168:171], v90, s[20:23], 0 offen
    v_add_u32 v91, v91, v2
    buffer_load_dwordx4 v[172:175], v91, s[20:23], 0 offen
    buffer_load_dword v63, v7, s[16:19], 0 offen sc1
    s_cmp_lg_u32 s70, 0
    s_cbranch_scc1 K_PLACE_SLOW
    v_alignbit_b32 v52, v96, v96, 20
    v_and_b32 v52, 0x1ff0, v52
    ds_read_b96 v[64:66], v52 offset:47104
    v_alignbit_b32 v53, v97, v97, 20
    v_and_b32 v53, 0x1ff0, v53
    ds_read_b96 v[68:70], v53 offset:47104
    v_alignbit_b32 v54, v98, v98, 20
    v_and_b32 v54, 0x1ff0, v54
    ds_read_b96 v[72:74], v54 offset:47104
    v_alignbit_b32 v55, v99, v99, 20
    v_and_b32 v55, 0x1ff0, v55
    ds_read_b96 v[76:78], v55 offset:47104
    v_lshlrev_b32 v56, 12, v96
    v_and_b32 v52, s67, v96
    v_bitop3_b32 v56, v52, v56, v51 bitop3:0x78
    v_lshlrev_b32 v57, 12, v97
    v_and_b32 v53, s67, v97
    v_bitop3_b32 v57, v53, v57, v51 bitop3:0x78
    v_lshlrev_b32 v58, 12, v98
    v_and_b32 v54, s67, v98
    v_bitop3_b32 v58, v54, v58, v51 bitop3:0x78
    v_lshlrev_b32 v59, 12, v99
    v_and_b32 v55, s67, v99
    v_bitop3_b32 v59, v55, v59, v51 bitop3:0x78
    s_waitcnt lgkmcnt(3)
    v_cmp_lt_u32 s[88:89], v112, v64
    s_waitcnt lgkmcnt(2)
    v_cmp_lt_u32 s[90:91], v113, v68
    s_waitcnt lgkmcnt(1)
    v_cmp_lt_u32 s[92:93], v114, v72
    s_waitcnt lgkmcnt(0)
    v_cmp_lt_u32 s[94:95], v115, v76
    v_cndmask_b32 v64, v66, v65, s[88:89]
    v_lshl_add_u32 v64, v112, 5, v64
    ds_write_b32 v64, v56
    v_cndmask_b32 v68, v70, v69, s[90:91]
    v_lshl_add_u32 v68, v113, 5, v68
    ds_write_b32 v68, v57
    v_cndmask_b32 v72, v74, v73, s[92:93]
    v_lshl_add_u32 v72, v114, 5, v72
    ds_write_b32 v72, v58
    v_cndmask_b32 v76, v78, v77, s[94:95]
    v_lshl_add_u32 v76, v115, 5, v76
    ds_write_b32 v76, v59
    v_cmp_gt_u32 vcc, s68, v100
    s_cbranch_vccz K_PLACE_DONE
    v_alignbit_b32 v52, v100, v100, 20
    v_and_b32 v52, 0x1ff0, v52
    ds_read_b96 v[64:66], v52 offset:47104
    v_alignbit_b32 v53, v101, v101, 20
    v_and_b32 v53, 0x1ff0, v53
    ds_read_b96 v[68:70], v53 offset:47104
    v_alignbit_b32 v54, v102, v102, 20
    v_and_b32 v54, 0x1ff0, v54
    ds_read_b96 v[72:74], v54 offset:47104
    v_alignbit_b32 v55, v103, v103, 20
    v_and_b32 v55, 0x1ff0, v55
    ds_read_b96 v[76:78], v55 offset:47104
    v_lshlrev_b32 v56, 12, v100
    v_and_b32 v52, s67, v100
    v_bitop3_b32 v56, v52, v56, v51 bitop3:0x78
    v_lshlrev_b32 v57, 12, v101
    v_and_b32 v53, s67, v101
    v_bitop3_b32 v57, v53, v57, v51 bitop3:0x78
    v_lshlrev_b32 v58, 12, v102
    v_and_b32 v54, s67, v102
    v_bitop3_b32 v58, v54, v58, v51 bitop3:0x78
    v_lshlrev_b32 v59, 12, v103
    v_and_b32 v55, s67, v103
    v_bitop3_b32 v59, v55, v59, v51 bitop3:0x78
    s_waitcnt lgkmcnt(3)
    v_cmp_lt_u32 s[88:89], v116, v64
    s_waitcnt lgkmcnt(2)
    v_cmp_lt_u32 s[90:91], v117, v68
    s_waitcnt lgkmcnt(1)
    v_cmp_lt_u32 s[92:93], v118, v72
    s_waitcnt lgkmcnt(0)
    v_cmp_lt_u32 s[94:95], v119, v76
    v_cndmask_b32 v64, v66, v65, s[88:89]
    v_lshl_add_u32 v64, v116, 5, v64
    ds_write_b32 v64, v56
    v_cndmask_b32 v68, v70, v69, s[90:91]
    v_lshl_add_u32 v68, v117, 5, v68
    ds_write_b32 v68, v57
    v_cndmask_b32 v72, v74, v73, s[92:93]
    v_lshl_add_u32 v72, v118, 5, v72
    ds_write_b32 v72, v58
    v_cndmask_b32 v76, v78, v77, s[94:95]
    v_lshl_add_u32 v76, v119, 5, v76
    ds_write_b32 v76, v59
    v_cmp_gt_u32 vcc, s68, v104
    s_cbranch_vccz K_PLACE_DONE
    v_alignbit_b32 v52, v104, v104, 20
    v_and_b32 v52, 0x1ff0, v52
    ds_read_b96 v[64:66], v52 offset:47104
    v_alignbit_b32 v53, v105, v105, 20
    v_and_b32 v53, 0x1ff0, v53
    ds_read_b96 v[68:70], v53 offset:47104
    v_alignbit_b32 v54, v106, v106, 20
    v_and_b32 v54, 0x1ff0, v54
    ds_read_b96 v[72:74], v54 offset:47104
    v_alignbit_b32 v55, v107, v107, 20
    v_and_b32 v55, 0x1ff0, v55
    ds_read_b96 v[76:78], v55 offset:47104
    v_lshlrev_b32 v56, 12, v104
    v_and_b32 v52, s67, v104
    v_bitop3_b32 v56, v52, v56, v51 bitop3:0x78
    v_lshlrev_b32 v57, 12, v105
    v_and_b32 v53, s67, v105
    v_bitop3_b32 v57, v53, v57, v51 bitop3:0x78
    v_lshlrev_b32 v58, 12, v106
    v_and_b32 v54, s67, v106
    v_bitop3_b32 v58, v54, v58, v51 bitop3:0x78
    v_lshlrev_b32 v59, 12, v107
    v_and_b32 v55, s67, v107
    v_bitop3_b32 v59, v55, v59, v51 bitop3:0x78
    s_waitcnt lgkmcnt(3)
    v_cmp_lt_u32 s[88:89], v120, v64
    s_waitcnt lgkmcnt(2)
    v_cmp_lt_u32 s[90:91], v121, v68
    s_waitcnt lgkmcnt(1)
    v_cmp_lt_u32 s[92:93], v122, v72
    s_waitcnt lgkmcnt(0)
    v_cmp_lt_u32 s[94:95], v123, v76
    v_cndmask_b32 v64, v66, v65, s[88:89]
    v_lshl_add_u32 v64, v120, 5, v64
    ds_write_b32 v64, v56
    v_cndmask_b32 v68, v70, v69, s[90:91]
    v_lshl_add_u32 v68, v121, 5, v68
    ds_write_b32 v68, v57
    v_cndmask_b32 v72, v74, v73, s[92:93]
    v_lshl_add_u32 v72, v122, 5, v72
    ds_write_b32 v72, v58
    v_cndmask_b32 v76, v78, v77, s[94:95]
    v_lshl_add_u32 v76, v123, 5, v76
    ds_write_b32 v76, v59
    v_cmp_gt_u32 vcc, s68, v108
    s_cbranch_vccz K_PLACE_DONE
    v_alignbit_b32 v52, v108, v108, 20
    v_and_b32 v52, 0x1ff0, v52
    ds_read_b96 v[64:66], v52 offset:47104
    v_alignbit_b32 v53, v109, v109, 20
    v_and_b32 v53, 0x1ff0, v53
    ds_read_b96 v[68:70], v53 offset:47104
    v_alignbit_b32 v54, v110, v110, 20
    v_and_b32 v54, 0x1ff0, v54
    ds_read_b96 v[72:74], v54 offset:47104
    v_alignbit_b32 v55, v111, v111, 20
    v_and_b32 v55, 0x1ff0, v55
    ds_read_b96 v[76:78], v55 offset:47104
    v_lshlrev_b32 v56, 12, v108
    v_and_b32 v52, s67, v108
    v_bitop3_b32 v56, v52, v56, v51 bitop3:0x78
    v_lshlrev_b32 v57, 12, v109
    v_and_b32 v53, s67, v109
    v_bitop3_b32 v57, v53, v57, v51 bitop3:0x78
    v_lshlrev_b32 v58, 12, v110
    v_and_b32 v54, s67, v110
    v_bitop3_b32 v58, v54, v58, v51 bitop3:0x78
    v_lshlrev_b32 v59, 12, v111
    v_and_b32 v55, s67, v111
    v_bitop3_b32 v59, v55, v59, v51 bitop3:0x78
    s_waitcnt lgkmcnt(3)
    v_cmp_lt_u32 s[88:89], v124, v64
    s_waitcnt lgkmcnt(2)
    v_cmp_lt_u32 s[90:91], v125, v68
    s_waitcnt lgkmcnt(1)
    v_cmp_lt_u32 s[92:93], v126, v72
    s_waitcnt lgkmcnt(0)
    v_cmp_lt_u32 s[94:95], v127, v76
    v_cndmask_b32 v64, v66, v65, s[88:89]
    v_lshl_add_u32 v64, v124, 5, v64
    ds_write_b32 v64, v56
    v_cndmask_b32 v68, v70, v69, s[90:91]
    v_lshl_add_u32 v68, v125, 5, v68
    ds_write_b32 v68, v57
    v_cndmask_b32 v72, v74, v73, s[92:93]
    v_lshl_add_u32 v72, v126, 5, v72
    ds_write_b32 v72, v58
    v_cndmask_b32 v76, v78, v77, s[94:95]
    v_lshl_add_u32 v76, v127, 5, v76
    ds_write_b32 v76, v59
    s_branch K_PLACE_DONE
K_PLACE_SLOW:
    s_mov_b64 exec, -1
    v_cmp_gt_u32 vcc, s68, v96
    s_cbranch_vccz K_PLACE_DONE
    v_alignbit_b32 v52, v96, v96, 20
    v_and_b32 v52, 0x1ff0, v52
    ds_read_b128 v[64:67], v52 offset:47104
    v_alignbit_b32 v52, v97, v97, 20
    v_and_b32 v52, 0x1ff0, v52
    ds_read_b128 v[68:71], v52 offset:47104
    v_alignbit_b32 v52, v98, v98, 20
    v_and_b32 v52, 0x1ff0, v52
    ds_read_b128 v[72:75], v52 offset:47104
    v_alignbit_b32 v52, v99, v99, 20
    v_and_b32 v52, 0x1ff0, v52
    ds_read_b128 v[76:79], v52 offset:47104
    s_cmp_lg_u32 s70, 0
    s_mov_b64 exec, -1
    v_cmp_gt_u32 vcc, s68, v96
    s_waitcnt lgkmcnt(3)
    s_mov_b64 exec, vcc
    v_lshlrev_b32 v54, 12, v96
    v_and_b32 v55, s67, v96
    v_cmp_lt_u32 vcc, v112, v64
    v_bitop3_b32 v55, v55, v54, v51 bitop3:0x78
    s_nop 0
    v_cndmask_b32 v53, v66, v65, vcc
    v_lshl_add_u32 v53, v112, 5, v53
    s_cbranch_scc1 K_PL00
K_PL00R:
    ds_write_b32 v53, v55
    s_mov_b64 exec, -1
    v_cmp_gt_u32 vcc, s68, v97
    s_waitcnt lgkmcnt(2)
    s_mov_b64 exec, vcc
    v_lshlrev_b32 v54, 12, v97
    v_and_b32 v55, s67, v97
    v_cmp_lt_u32 vcc, v113, v68
    v_bitop3_b32 v55, v55, v54, v51 bitop3:0x78
    s_nop 0
    v_cndmask_b32 v53, v70, v69, vcc
    v_lshl_add_u32 v53, v113, 5, v53
    s_cbranch_scc1 K_PL01
K_PL01R:
    ds_write_b32 v53, v55
    s_mov_b64 exec, -1
    v_cmp_gt_u32 vcc, s68, v98
    s_waitcnt lgkmcnt(1)
    s_mov_b64 exec, vcc
    v_lshlrev_b32 v54, 12, v98
    v_and_b32 v55, s67, v98
    v_cmp_lt_u32 vcc, v114, v72
    v_bitop3_b32 v55, v55, v54, v51 bitop3:0x78
    s_nop 0
    v_cndmask_b32 v53, v74, v73, vcc
    v_lshl_add_u32 v53, v114, 5, v53
    s_cbranch_scc1 K_PL02
K_PL02R:
    ds_write_b32 v53, v55
    s_mov_b64 exec, -1
    v_cmp_gt_u32 vcc, s68, v99
    s_waitcnt lgkmcnt(0)
    s_mov_b64 exec, vcc
    v_lshlrev_b32 v54, 12, v99
    v_and_b32 v55, s67, v99
    v_cmp_lt_u32 vcc, v115, v76
    v_bitop3_b32 v55, v55, v54, v51 bitop3:0x78
    s_nop 0
    v_cndmask_b32 v53, v78, v77, vcc
    v_lshl_add_u32 v53, v115, 5, v53
    s_cbranch_scc1 K_PL03
K_PL03R:
    ds_write_b32 v53, v55
    s_mov_b64 exec, -1
    v_cmp_gt_u32 vcc, s68, v100
    s_cbranch_vccz K_PLACE_DONE
    v_alignbit_b32 v52, v100, v100, 20
    v_and_b32 v52, 0x1ff0, v52
    ds_read_b128 v[64:67], v52 offset:47104
    v_alignbit_b32 v52, v101, v101, 20
    v_and_b32 v52, 0x1ff0, v52
    ds_read_b128 v[68:71], v52 offset:47104
    v_alignbit_b32 v52, v102, v102, 20
    v_and_b32 v52, 0x1ff0, v52
    ds_read_b128 v[72:75], v52 offset:47104
    v_alignbit_b32 v52, v103, v103, 20
    v_and_b32 v52, 0x1ff0, v52
    ds_read_b128 v[76:79], v52 offset:47104
    s_cmp_lg_u32 s70, 0
    s_mov_b64 exec, -1
    v_cmp_gt_u32 vcc, s68, v100
    s_waitcnt lgkmcnt(3)
    s_mov_b64 exec, vcc
    v_lshlrev_b32 v54, 12, v100
    v_and_b32 v55, s67, v100
    v_cmp_lt_u32 vcc, v116, v64
    v_bitop3_b32 v55, v55, v54, v51 bitop3:0x78
    s_nop 0
    v_cndmask_b32 v53, v66, v65, vcc
    v_lshl_add_u32 v53, v116, 5, v53
    s_cbranch_scc1 K_PL10
K_PL10R:
    ds_write_b32 v53, v55
    s_mov_b64 exec, -1
    v_cmp_gt_u32 vcc, s68, v101
    s_waitcnt lgkmcnt(2)
    s_mov_b64 exec, vcc
    v_lshlrev_b32 v54, 12, v101
    v_and_b32 v55, s67, v101
    v_cmp_lt_u32 vcc, v117, v68
    v_bitop3_b32 v55, v55, v54, v51 bitop3:0x78
    s_nop 0
    v_cndmask_b32 v53, v70, v69, vcc
    v_lshl_add_u32 v53, v117, 5, v53
    s_cbranch_scc1 K_PL11
K_PL11R:
    ds_write_b32 v53, v55
    s_mov_b64 exec, -1
    v_cmp_gt_u32 vcc, s68, v102
    s_waitcnt lgkmcnt(1)
    s_mov_b64 exec, vcc
    v_lshlrev_b32 v54, 12, v102
    v_and_b32 v55, s67, v102
    v_cmp_lt_u32 vcc, v118, v72
    v_bitop3_b32 v55, v55, v54, v51 bitop3:0x78
    s_nop 0
    v_cndmask_b32 v53, v74, v73, vcc
    v_lshl_add_u32 v53, v118, 5, v53
    s_cbranch_scc1 K_PL12
K_PL12R:
    ds_write_b32 v53, v55
    s_mov_b64 exec, -1
    v_cmp_gt_u32 vcc, s68, v103
    s_waitcnt lgkmcnt(0)
    s_mov_b64 exec, vcc
    v_lshlrev_b32 v54, 12, v103
    v_and_b32 v55, s67, v103
    v_cmp_lt_u32 vcc, v119, v76
    v_bitop3_b32 v55, v55, v54, v51 bitop3:0x78
    s_nop 0
    v_cndmask_b32 v53, v78, v77, vcc
    v_lshl_add_u32 v53, v119, 5, v53
    s_cbranch_scc1 K_PL13
K_PL13R:
    ds_write_b32 v53, v55
    s_mov_b64 exec, -1
    v_cmp_gt_u32 vcc, s68, v104
    s_cbranch_vccz K_PLACE_DONE
    v_alignbit_b32 v52, v104, v104, 20
    v_and_b32 v52, 0x1ff0, v52
    ds_read_b128 v[64:67], v52 offset:47104
    v_alignbit_b32 v52, v105, v105, 20
    v_and_b32 v52, 0x1ff0, v52
    ds_read_b128 v[68:71], v52 offset:47104
    v_alignbit_b32 v52, v106, v106, 20
    v_and_b32 v52, 0x1ff0, v52
    ds_read_b128 v[72:75], v52 offset:47104
    v_alignbit_b32 v52, v107, v107, 20
    v_and_b32 v52, 0x1ff0, v52
    ds_read_b128 v[76:79], v52 offset:47104
    s_cmp_lg_u32 s70, 0
    s_mov_b64 exec, -1
    v_cmp_gt_u32 vcc, s68, v104
    s_waitcnt lgkmcnt(3)
    s_mov_b64 exec, vcc
    v_lshlrev_b32 v54, 12, v104
    v_and_b32 v55, s67, v104
    v_cmp_lt_u32 vcc, v120, v64
    v_bitop3_b32 v55, v55, v54, v51 bitop3:0x78
    s_nop 0
    v_cndmask_b32 v53, v66, v65, vcc
    v_lshl_add_u32 v53, v120, 5, v53
    s_cbranch_scc1 K_PL20
K_PL20R:
    ds_write_b32 v53, v55
    s_mov_b64 exec, -1
    v_cmp_gt_u32 vcc, s68, v105
    s_waitcnt lgkmcnt(2)
    s_mov_b64 exec, vcc
    v_lshlrev_b32 v54, 12, v105
    v_and_b32 v55, s67, v105
    v_cmp_lt_u32 vcc, v121, v68
    v_bitop3_b32 v55, v55, v54, v51 bitop3:0x78
    s_nop 0
    v_cndmask_b32 v53, v70, v69, vcc
    v_lshl_add_u32 v53, v121, 5, v53
    s_cbranch_scc1 K_PL21
K_PL21R:
    ds_write_b32 v53, v55
    s_mov_b64 exec, -1
    v_cmp_gt_u32 vcc, s68, v106
    s_waitcnt lgkmcnt(1)
    s_mov_b64 exec, vcc
    v_lshlrev_b32 v54, 12, v106
    v_and_b32 v55, s67, v106
    v_cmp_lt_u32 vcc, v122, v72
    v_bitop3_b32 v55, v55, v54, v51 bitop3:0x78
    s_nop 0
    v_cndmask_b32 v53, v74, v73, vcc
    v_lshl_add_u32 v53, v122, 5, v53
    s_cbranch_scc1 K_PL22
K_PL22R:
    ds_write_b32 v53, v55
    s_mov_b64 exec, -1
    v_cmp_gt_u32 vcc, s68, v107
    s_waitcnt lgkmcnt(0)
    s_mov_b64 exec, vcc
    v_lshlrev_b32 v54, 12, v107
    v_and_b32 v55, s67, v107
    v_cmp_lt_u32 vcc, v123, v76
    v_bitop3_b32 v55, v55, v54, v51 bitop3:0x78
    s_nop 0
    v_cndmask_b32 v53, v78, v77, vcc
    v_lshl_add_u32 v53, v123, 5, v53
    s_cbranch_scc1 K_PL23
K_PL23R:
    ds_write_b32 v53, v55
    s_mov_b64 exec, -1
    v_cmp_gt_u32 vcc, s68, v108
    s_cbranch_vccz K_PLACE_DONE
    v_alignbit_b32 v52, v108, v108, 20
    v_and_b32 v52, 0x1ff0, v52
    ds_read_b128 v[64:67], v52 offset:47104
    v_alignbit_b32 v52, v109, v109, 20
    v_and_b32 v52, 0x1ff0, v52
    ds_read_b128 v[68:71], v52 offset:47104
    v_alignbit_b32 v52, v110, v110, 20
    v_and_b32 v52, 0x1ff0, v52
    ds_read_b128 v[72:75], v52 offset:47104
    v_alignbit_b32 v52, v111, v111, 20
    v_and_b32 v52, 0x1ff0, v52
    ds_read_b128 v[76:79], v52 offset:47104
    s_cmp_lg_u32 s70, 0
    s_mov_b64 exec, -1
    v_cmp_gt_u32 vcc, s68, v108
    s_waitcnt lgkmcnt(3)
    s_mov_b64 exec, vcc
    v_lshlrev_b32 v54, 12, v108
    v_and_b32 v55, s67, v108
    v_cmp_lt_u32 vcc, v124, v64
    v_bitop3_b32 v55, v55, v54, v51 bitop3:0x78
    s_nop 0
    v_cndmask_b32 v53, v66, v65, vcc
    v_lshl_add_u32 v53, v124, 5, v53
    s_cbranch_scc1 K_PL30
K_PL30R:
    ds_write_b32 v53, v55
    s_mov_b64 exec, -1
    v_cmp_gt_u32 vcc, s68, v109
    s_waitcnt lgkmcnt(2)
    s_mov_b64 exec, vcc
    v_lshlrev_b32 v54, 12, v109
    v_and_b32 v55, s67, v109
    v_cmp_lt_u32 vcc, v125, v68
    v_bitop3_b32 v55, v55, v54, v51 bitop3:0x78
    s_nop 0
    v_cndmask_b32 v53, v70, v69, vcc
    v_lshl_add_u32 v53, v125, 5, v53
    s_cbranch_scc1 K_PL31
K_PL31R:
    ds_write_b32 v53, v55
    s_mov_b64 exec, -1
    v_cmp_gt_u32 vcc, s68, v110
    s_waitcnt lgkmcnt(1)
    s_mov_b64 exec, vcc
    v_lshlrev_b32 v54, 12, v110
    v_and_b32 v55, s67, v110
    v_cmp_lt_u32 vcc, v126, v72
    v_bitop3_b32 v55, v55, v54, v51 bitop3:0x78
    s_nop 0
    v_cndmask_b32 v53, v74, v73, vcc
    v_lshl_add_u32 v53, v126, 5, v53
    s_cbranch_scc1 K_PL32
K_PL32R:
    ds_write_b32 v53, v55
    s_mov_b64 exec, -1
    v_cmp_gt_u32 vcc, s68, v111
    s_waitcnt lgkmcnt(0)
    s_mov_b64 exec, vcc
    v_lshlrev_b32 v54, 12, v111
    v_and_b32 v55, s67, v111
    v_cmp_lt_u32 vcc, v127, v76
    v_bitop3_b32 v55, v55, v54, v51 bitop3:0x78
    s_nop 0
    v_cndmask_b32 v53, v78, v77, vcc
    v_lshl_add_u32 v53, v127, 5, v53
    s_cbranch_scc1 K_PL33
K_PL33R:
    ds_write_b32 v53, v55
K_PLACE_DONE:
    s_mov_b64 exec, -1
    v_cmp_eq_u32 vcc, 0xfffffffe, v111
    s_cbranch_vccz K_OP_X
    v_lshlrev_b32 v54, 2, v24
    v_cndmask_b32 v54, v36, v54, vcc
    s_mov_b32 s62, 528384
    s_mov_b32 s18, 529408
    buffer_load_dword v55, v54, s[16:19], s62 offen sc1
    s_mov_b32 s18, 0x60000
    v_lshlrev_b32 v54, 15, v24
    s_waitcnt vmcnt(0)
K_OP_L:
    v_cmp_lt_i32 vcc, 0, v55
    s_cbranch_vccz K_OP_X
    s_mov_b64 exec, vcc
    buffer_load_dwordx2 v[56:57], v54, s[84:87], 0 offen sc1
    v_add_u32 v54, 8, v54
    v_subrev_u32 v55, 1, v55
    s_waitcnt vmcnt(0)
    v_cmp_eq_u32 vcc, v57, v46
    s_mov_b64 exec, vcc
    v_alignbit_b32 v52, v56, v56, 22
    v_and_b32 v52, 0x7fc, v52
    ds_read_b32 v58, v52 offset:34816
    ds_add_rtn_u32 v59, v52, v50 offset:38912
    v_lshlrev_b32 v52, 2, v52
    ds_read_b128 v[64:67], v52 offset:47104
    s_waitcnt lgkmcnt(0)
    v_add_u32 v59, v59, v58
    s_cmp_lg_u32 s70, 0
    v_lshlrev_b32 v60, 12, v56
    v_and_b32 v61, s67, v56
    v_cmp_lt_u32 vcc, v59, v64
    v_bitop3_b32 v61, v61, v60, v51 bitop3:0x78
    s_nop 0
    v_cndmask_b32 v53, v66, v65, vcc
    v_lshl_add_u32 v53, v59, 5, v53
    s_cbranch_scc1 K_PLT
K_PLTR:
    ds_write_b32 v53, v61
    s_mov_b64 exec, -1
    s_branch K_OP_L
K_OP_X:
    s_mov_b64 exec, -1
    v_lshrrev_b32 v52, 3, v1
    v_lshlrev_b32 v52, 3, v52
    v_add_u32 v0, s71, v52
    s_add_u32 s46, s48, s49
    s_add_u32 s46, s46, s50
    s_add_u32 s46, s46, s51
    s_add_u32 s47, s52, s53
    s_add_u32 s47, s47, s54
    s_add_u32 s47, s47, s55
    s_cmp_eq_u32 s48, 0
    s_cselect_b32 s78, s49, s48
    s_cselect_b32 s79, s53, s52
    s_mov_b32 s38, s78
    s_mov_b32 s36, 0
    s_mov_b32 s37, 0
    s_mov_b32 s39, 0
    s_mov_b32 s41, 0
    s_mov_b32 s42, 0
    s_mov_b32 s43, 1
    s_mov_b32 s44, 0
    s_mov_b32 s45, 1
    s_lshr_b32 s40, 0, s3
    s_and_b32 s40, s40, 1
    s_sub_u32 s40, 8, s40
    v_mov_b32 v40, v23
    v_lshlrev_b32 v224, 4, v1
    v_add_u32 v224, 76800, v224
    v_add_u32 v224, s76, v224
    s_lshl_b32 s62, s3, 2
    s_add_u32 s62, s62, 161984
    v_mov_b32 v252, s62
    s_mov_b32 s56, 1
    s_add_u32 s24, s6, 0x7182000
    s_addc_u32 s25, s7, 0
    s_mov_b32 s26, 0x4800
    s_mov_b32 s27, 0x20000
    s_mov_b32 s66, 0
    s_cmp_lg_u32 s3, 7
    s_cbranch_scc1 K_NOE0
    s_waitcnt vmcnt(0)
    v_cmp_le_u32 vcc, 16, v63
    s_cmp_eq_u64 vcc, -1
    s_cbranch_scc0 K_NOE0
    v_mov_b32 v52, 161696
    ds_write_b32 v52, v50
    s_add_u32 s66, s66, 1
K_NOE0:
    s_cmp_eq_u32 s70, 0
    s_cbranch_scc1 K_NOW
    s_waitcnt vmcnt(0)
K_NOW:
    s_waitcnt lgkmcnt(0)
    s_barrier
K_ENGINE:
    s_setprio 2
    s_cmp_eq_u32 s3, 7
    s_cbranch_scc1 HELPER
    s_cmp_eq_u32 s48, 0
    s_cbranch_scc1 S10
S00:
    s_cmp_lg_u32 s41, 7
    s_cbranch_scc1 SLOW00
    s_waitcnt vmcnt(4)
C00:
    v_mfma_f32_16x16x32_bf16 v[128:131], v[8:11], v[24:27], v[128:131]
    v_mfma_f32_16x16x32_bf16 v[132:135], v[8:11], v[28:31], v[132:135]
    s_add_u32 s36, s36, 1
    s_cmp_eq_u32 s36, s38
    s_cbranch_scc1 EV00
P00:
    s_cmp_eq_u32 s37, s39
    s_cbranch_scc1 XSYNC00
I00:
    s_waitcnt lgkmcnt(0)
    v_add_u32 v14, v12, v2
    v_add_u32 v15, v13, v2
    v_add_u32 v3, 64, v3
    buffer_load_dwordx4 v[24:27], v14, s[8:11], 0 offen sc1
    buffer_load_dwordx4 v[28:31], v15, s[8:11], 0 offen sc1
    ds_read_b64 v[12:13], v3
    s_add_u32 s37, s37, 1
S01:
    s_cmp_lg_u32 s41, 7
    s_cbranch_scc1 SLOW01
    s_waitcnt vmcnt(4)
C01:
    v_mfma_f32_16x16x32_bf16 v[128:131], v[8:11], v[32:35], v[128:131]
    v_mfma_f32_16x16x32_bf16 v[132:135], v[8:11], v[36:39], v[132:135]
    s_add_u32 s36, s36, 1
    s_cmp_eq_u32 s36, s38
    s_cbranch_scc1 EV01
P01:
    s_cmp_eq_u32 s37, s39
    s_cbranch_scc1 XSYNC01
I01:
    s_waitcnt lgkmcnt(0)
    v_add_u32 v14, v12, v2
    v_add_u32 v15, v13, v2
    v_add_u32 v3, 64, v3
    buffer_load_dwordx4 v[32:35], v14, s[8:11], 0 offen sc1
    buffer_load_dwordx4 v[36:39], v15, s[8:11], 0 offen sc1
    ds_read_b64 v[12:13], v3
    s_add_u32 s37, s37, 1
S02:
    s_cmp_lg_u32 s41, 7
    s_cbranch_scc1 SLOW02
    s_waitcnt vmcnt(4)
C02:
    v_mfma_f32_16x16x32_bf16 v[128:131], v[8:11], v[40:43], v[128:131]
    v_mfma_f32_16x16x32_bf16 v[132:135], v[8:11], v[44:47], v[132:135]
    s_add_u32 s36, s36, 1
    s_cmp_eq_u32 s36, s38
    s_cbranch_scc1 EV02
P02:
    s_cmp_eq_u32 s37, s39
    s_cbranch_scc1 XSYNC02
I02:
    s_waitcnt lgkmcnt(0)
    v_add_u32 v14, v12, v2
    v_add_u32 v15, v13, v2
    v_add_u32 v3, 64, v3
    buffer_load_dwordx4 v[40:43], v14, s[8:11], 0 offen sc1
    buffer_load_dwordx4 v[44:47], v15, s[8:11], 0 offen sc1
    ds_read_b64 v[12:13], v3
    s_add_u32 s37, s37, 1
    s_branch S00
S10:
    s_cmp_lg_u32 s41, 7
    s_cbranch_scc1 SLOW10
    s_waitcnt vmcnt(4)
C10:
    v_mfma_f32_16x16x32_bf16 v[136:139], v[8:11], v[24:27], v[136:139]
    v_mfma_f32_16x16x32_bf16 v[140:143], v[8:11], v[28:31], v[140:143]
    s_add_u32 s36, s36, 1
    s_cmp_eq_u32 s36, s38
    s_cbranch_scc1 EV10
P10:
    s_cmp_eq_u32 s37, s39
    s_cbranch_scc1 XSYNC10
I10:
    s_waitcnt lgkmcnt(0)
    v_add_u32 v14, v12, v2
    v_add_u32 v15, v13, v2
    v_add_u32 v3, 64, v3
    buffer_load_dwordx4 v[24:27], v14, s[8:11], 0 offen sc1
    buffer_load_dwordx4 v[28:31], v15, s[8:11], 0 offen sc1
    ds_read_b64 v[12:13], v3
    s_add_u32 s37, s37, 1
S11:
    s_cmp_lg_u32 s41, 7
    s_cbranch_scc1 SLOW11
    s_waitcnt vmcnt(4)
C11:
    v_mfma_f32_16x16x32_bf16 v[136:139], v[8:11], v[32:35], v[136:139]
    v_mfma_f32_16x16x32_bf16 v[140:143], v[8:11], v[36:39], v[140:143]
    s_add_u32 s36, s36, 1
    s_cmp_eq_u32 s36, s38
    s_cbranch_scc1 EV11
P11:
    s_cmp_eq_u32 s37, s39
    s_cbranch_scc1 XSYNC11
I11:
    s_waitcnt lgkmcnt(0)
    v_add_u32 v14, v12, v2
    v_add_u32 v15, v13, v2
    v_add_u32 v3, 64, v3
    buffer_load_dwordx4 v[32:35], v14, s[8:11], 0 offen sc1
    buffer_load_dwordx4 v[36:39], v15, s[8:11], 0 offen sc1
    ds_read_b64 v[12:13], v3
    s_add_u32 s37, s37, 1
S12:
    s_cmp_lg_u32 s41, 7
    s_cbranch_scc1 SLOW12
    s_waitcnt vmcnt(4)
C12:
    v_mfma_f32_16x16x32_bf16 v[136:139], v[8:11], v[40:43], v[136:139]
    v_mfma_f32_16x16x32_bf16 v[140:143], v[8:11], v[44:47], v[140:143]
    s_add_u32 s36, s36, 1
    s_cmp_eq_u32 s36, s38
    s_cbranch_scc1 EV12
P12:
    s_cmp_eq_u32 s37, s39
    s_cbranch_scc1 XSYNC12
I12:
    s_waitcnt lgkmcnt(0)
    v_add_u32 v14, v12, v2
    v_add_u32 v15, v13, v2
    v_add_u32 v3, 64, v3
    buffer_load_dwordx4 v[40:43], v14, s[8:11], 0 offen sc1
    buffer_load_dwordx4 v[44:47], v15, s[8:11], 0 offen sc1
    ds_read_b64 v[12:13], v3
    s_add_u32 s37, s37, 1
    s_branch S10
S20:
    s_cmp_lg_u32 s41, 7
    s_cbranch_scc1 SLOW20
    s_waitcnt vmcnt(4)
C20:
    v_mfma_f32_16x16x32_bf16 v[144:147], v[8:11], v[24:27], v[144:147]
    v_mfma_f32_16x16x32_bf16 v[148:151], v[8:11], v[28:31], v[148:151]
    s_add_u32 s36, s36, 1
    s_cmp_eq_u32 s36, s38
    s_cbranch_scc1 EV20
P20:
    s_cmp_eq_u32 s37, s39
    s_cbranch_scc1 XSYNC20
I20:
    s_waitcnt lgkmcnt(0)
    v_add_u32 v14, v12, v2
    v_add_u32 v15, v13, v2
    v_add_u32 v3, 64, v3
    buffer_load_dwordx4 v[24:27], v14, s[8:11], 0 offen sc1
    buffer_load_dwordx4 v[28:31], v15, s[8:11], 0 offen sc1
    ds_read_b64 v[12:13], v3
    s_add_u32 s37, s37, 1
S21:
    s_cmp_lg_u32 s41, 7
    s_cbranch_scc1 SLOW21
    s_waitcnt vmcnt(4)
C21:
    v_mfma_f32_16x16x32_bf16 v[144:147], v[8:11], v[32:35], v[144:147]
    v_mfma_f32_16x16x32_bf16 v[148:151], v[8:11], v[36:39], v[148:151]
    s_add_u32 s36, s36, 1
    s_cmp_eq_u32 s36, s38
    s_cbranch_scc1 EV21
P21:
    s_cmp_eq_u32 s37, s39
    s_cbranch_scc1 XSYNC21
I21:
    s_waitcnt lgkmcnt(0)
    v_add_u32 v14, v12, v2
    v_add_u32 v15, v13, v2
    v_add_u32 v3, 64, v3
    buffer_load_dwordx4 v[32:35], v14, s[8:11], 0 offen sc1
    buffer_load_dwordx4 v[36:39], v15, s[8:11], 0 offen sc1
    ds_read_b64 v[12:13], v3
    s_add_u32 s37, s37, 1
S22:
    s_cmp_lg_u32 s41, 7
    s_cbranch_scc1 SLOW22
    s_waitcnt vmcnt(4)
C22:
    v_mfma_f32_16x16x32_bf16 v[144:147], v[8:11], v[40:43], v[144:147]
    v_mfma_f32_16x16x32_bf16 v[148:151], v[8:11], v[44:47], v[148:151]
    s_add_u32 s36, s36, 1
    s_cmp_eq_u32 s36, s38
    s_cbranch_scc1 EV22
P22:
    s_cmp_eq_u32 s37, s39
    s_cbranch_scc1 XSYNC22
I22:
    s_waitcnt lgkmcnt(0)
    v_add_u32 v14, v12, v2
    v_add_u32 v15, v13, v2
    v_add_u32 v3, 64, v3
    buffer_load_dwordx4 v[40:43], v14, s[8:11], 0 offen sc1
    buffer_load_dwordx4 v[44:47], v15, s[8:11], 0 offen sc1
    ds_read_b64 v[12:13], v3
    s_add_u32 s37, s37, 1
    s_branch S20
S30:
    s_cmp_lg_u32 s41, 7
    s_cbranch_scc1 SLOW30
    s_waitcnt vmcnt(4)
C30:
    v_mfma_f32_16x16x32_bf16 v[152:155], v[8:11], v[24:27], v[152:155]
    v_mfma_f32_16x16x32_bf16 v[156:159], v[8:11], v[28:31], v[156:159]
    s_add_u32 s36, s36, 1
    s_cmp_eq_u32 s36, s38
    s_cbranch_scc1 EV30
P30:
    s_cmp_eq_u32 s37, s39
    s_cbranch_scc1 XSYNC30
I30:
    s_waitcnt lgkmcnt(0)
    v_add_u32 v14, v12, v2
    v_add_u32 v15, v13, v2
    v_add_u32 v3, 64, v3
    buffer_load_dwordx4 v[24:27], v14, s[8:11], 0 offen sc1
    buffer_load_dwordx4 v[28:31], v15, s[8:11], 0 offen sc1
    ds_read_b64 v[12:13], v3
    s_add_u32 s37, s37, 1
S31:
    s_cmp_lg_u32 s41, 7
    s_cbranch_scc1 SLOW31
    s_waitcnt vmcnt(4)
C31:
    v_mfma_f32_16x16x32_bf16 v[152:155], v[8:11], v[32:35], v[152:155]
    v_mfma_f32_16x16x32_bf16 v[156:159], v[8:11], v[36:39], v[156:159]
    s_add_u32 s36, s36, 1
    s_cmp_eq_u32 s36, s38
    s_cbranch_scc1 EV31
P31:
    s_cmp_eq_u32 s37, s39
    s_cbranch_scc1 XSYNC31
I31:
    s_waitcnt lgkmcnt(0)
    v_add_u32 v14, v12, v2
    v_add_u32 v15, v13, v2
    v_add_u32 v3, 64, v3
    buffer_load_dwordx4 v[32:35], v14, s[8:11], 0 offen sc1
    buffer_load_dwordx4 v[36:39], v15, s[8:11], 0 offen sc1
    ds_read_b64 v[12:13], v3
    s_add_u32 s37, s37, 1
S32:
    s_cmp_lg_u32 s41, 7
    s_cbranch_scc1 SLOW32
    s_waitcnt vmcnt(4)
C32:
    v_mfma_f32_16x16x32_bf16 v[152:155], v[8:11], v[40:43], v[152:155]
    v_mfma_f32_16x16x32_bf16 v[156:159], v[8:11], v[44:47], v[156:159]
    s_add_u32 s36, s36, 1
    s_cmp_eq_u32 s36, s38
    s_cbranch_scc1 EV32
P32:
    s_cmp_eq_u32 s37, s39
    s_cbranch_scc1 XSYNC32
I32:
    s_waitcnt lgkmcnt(0)
    v_add_u32 v14, v12, v2
    v_add_u32 v15, v13, v2
    v_add_u32 v3, 64, v3
    buffer_load_dwordx4 v[40:43], v14, s[8:11], 0 offen sc1
    buffer_load_dwordx4 v[44:47], v15, s[8:11], 0 offen sc1
    ds_read_b64 v[12:13], v3
    s_add_u32 s37, s37, 1
    s_branch S30
SLOW00:
    s_bitcmp1_b32 s41, 0
    s_cbranch_scc0 NL00
    s_waitcnt vmcnt(0)
    s_branch C00
NL00:
    s_bitset1_b32 s41, 0
    s_branch P00
XSYNC00:
    s_call_b64 s[58:59], SYNC
    s_cbranch_scc1 I00
    s_bitset0_b32 s41, 0
    s_branch S01
EV00:
    s_cmp_eq_u32 s42, 0
    s_cbranch_scc0 EVB00
    s_add_u32 s38, s38, s49
    s_branch P10
EVB00:
    s_cmp_eq_u32 s37, s39
    s_cbranch_scc1 EVC00
    s_waitcnt lgkmcnt(0)
    v_add_u32 v14, v12, v2
    v_add_u32 v15, v13, v2
    v_add_u32 v3, 64, v3
    buffer_load_dwordx4 v[24:27], v14, s[8:11], 0 offen sc1
    buffer_load_dwordx4 v[28:31], v15, s[8:11], 0 offen sc1
    ds_read_b64 v[12:13], v3
    s_add_u32 s37, s37, 1
    s_call_b64 s[58:59], FIN0
    s_add_u32 s38, s38, s53
    s_branch S11
EVC00:
    s_call_b64 s[58:59], FIN0
    s_add_u32 s38, s38, s53
    s_branch P10
SLOW01:
    s_bitcmp1_b32 s41, 1
    s_cbranch_scc0 NL01
    s_waitcnt vmcnt(0)
    s_branch C01
NL01:
    s_bitset1_b32 s41, 1
    s_branch P01
XSYNC01:
    s_call_b64 s[58:59], SYNC
    s_cbranch_scc1 I01
    s_bitset0_b32 s41, 1
    s_branch S02
EV01:
    s_cmp_eq_u32 s42, 0
    s_cbranch_scc0 EVB01
    s_add_u32 s38, s38, s49
    s_branch P11
EVB01:
    s_cmp_eq_u32 s37, s39
    s_cbranch_scc1 EVC01
    s_waitcnt lgkmcnt(0)
    v_add_u32 v14, v12, v2
    v_add_u32 v15, v13, v2
    v_add_u32 v3, 64, v3
    buffer_load_dwordx4 v[32:35], v14, s[8:11], 0 offen sc1
    buffer_load_dwordx4 v[36:39], v15, s[8:11], 0 offen sc1
    ds_read_b64 v[12:13], v3
    s_add_u32 s37, s37, 1
    s_call_b64 s[58:59], FIN0
    s_add_u32 s38, s38, s53
    s_branch S12
EVC01:
    s_call_b64 s[58:59], FIN0
    s_add_u32 s38, s38, s53
    s_branch P11
SLOW02:
    s_bitcmp1_b32 s41, 2
    s_cbranch_scc0 NL02
    s_waitcnt vmcnt(0)
    s_branch C02
NL02:
    s_bitset1_b32 s41, 2
    s_branch P02
XSYNC02:
    s_call_b64 s[58:59], SYNC
    s_cbranch_scc1 I02
    s_bitset0_b32 s41, 2
    s_branch S00
EV02:
    s_cmp_eq_u32 s42, 0
    s_cbranch_scc0 EVB02
    s_add_u32 s38, s38, s49
    s_branch P12
EVB02:
    s_cmp_eq_u32 s37, s39
    s_cbranch_scc1 EVC02
    s_waitcnt lgkmcnt(0)
    v_add_u32 v14, v12, v2
    v_add_u32 v15, v13, v2
    v_add_u32 v3, 64, v3
    buffer_load_dwordx4 v[40:43], v14, s[8:11], 0 offen sc1
    buffer_load_dwordx4 v[44:47], v15, s[8:11], 0 offen sc1
    ds_read_b64 v[12:13], v3
    s_add_u32 s37, s37, 1
    s_call_b64 s[58:59], FIN0
    s_add_u32 s38, s38, s53
    s_branch S10
EVC02:
    s_call_b64 s[58:59], FIN0
    s_add_u32 s38, s38, s53
    s_branch P12
SLOW10:
    s_bitcmp1_b32 s41, 0
    s_cbranch_scc0 NL10
    s_waitcnt vmcnt(0)
    s_branch C10
NL10:
    s_bitset1_b32 s41, 0
    s_branch P10
XSYNC10:
    s_call_b64 s[58:59], SYNC
    s_cbranch_scc1 I10
    s_bitset0_b32 s41, 0
    s_branch S11
EV10:
    s_cmp_eq_u32 s42, 0
    s_cbranch_scc0 EVB10
    s_add_u32 s38, s38, s50
    s_branch P20
EVB10:
    s_cmp_eq_u32 s37, s39
    s_cbranch_scc1 EVC10
    s_waitcnt lgkmcnt(0)
    v_add_u32 v14, v12, v2
    v_add_u32 v15, v13, v2
    v_add_u32 v3, 64, v3
    buffer_load_dwordx4 v[24:27], v14, s[8:11], 0 offen sc1
    buffer_load_dwordx4 v[28:31], v15, s[8:11], 0 offen sc1
    ds_read_b64 v[12:13], v3
    s_add_u32 s37, s37, 1
    s_call_b64 s[58:59], FIN1
    s_add_u32 s38, s38, s54
    s_branch S21
EVC10:
    s_call_b64 s[58:59], FIN1
    s_add_u32 s38, s38, s54
    s_branch P20
SLOW11:
    s_bitcmp1_b32 s41, 1
    s_cbranch_scc0 NL11
    s_waitcnt vmcnt(0)
    s_branch C11
NL11:
    s_bitset1_b32 s41, 1
    s_branch P11
XSYNC11:
    s_call_b64 s[58:59], SYNC
    s_cbranch_scc1 I11
    s_bitset0_b32 s41, 1
    s_branch S12
EV11:
    s_cmp_eq_u32 s42, 0
    s_cbranch_scc0 EVB11
    s_add_u32 s38, s38, s50
    s_branch P21
EVB11:
    s_cmp_eq_u32 s37, s39
    s_cbranch_scc1 EVC11
    s_waitcnt lgkmcnt(0)
    v_add_u32 v14, v12, v2
    v_add_u32 v15, v13, v2
    v_add_u32 v3, 64, v3
    buffer_load_dwordx4 v[32:35], v14, s[8:11], 0 offen sc1
    buffer_load_dwordx4 v[36:39], v15, s[8:11], 0 offen sc1
    ds_read_b64 v[12:13], v3
    s_add_u32 s37, s37, 1
    s_call_b64 s[58:59], FIN1
    s_add_u32 s38, s38, s54
    s_branch S22
EVC11:
    s_call_b64 s[58:59], FIN1
    s_add_u32 s38, s38, s54
    s_branch P21
SLOW12:
    s_bitcmp1_b32 s41, 2
    s_cbranch_scc0 NL12
    s_waitcnt vmcnt(0)
    s_branch C12
NL12:
    s_bitset1_b32 s41, 2
    s_branch P12
XSYNC12:
    s_call_b64 s[58:59], SYNC
    s_cbranch_scc1 I12
    s_bitset0_b32 s41, 2
    s_branch S10
EV12:
    s_cmp_eq_u32 s42, 0
    s_cbranch_scc0 EVB12
    s_add_u32 s38, s38, s50
    s_branch P22
EVB12:
    s_cmp_eq_u32 s37, s39
    s_cbranch_scc1 EVC12
    s_waitcnt lgkmcnt(0)
    v_add_u32 v14, v12, v2
    v_add_u32 v15, v13, v2
    v_add_u32 v3, 64, v3
    buffer_load_dwordx4 v[40:43], v14, s[8:11], 0 offen sc1
    buffer_load_dwordx4 v[44:47], v15, s[8:11], 0 offen sc1
    ds_read_b64 v[12:13], v3
    s_add_u32 s37, s37, 1
    s_call_b64 s[58:59], FIN1
    s_add_u32 s38, s38, s54
    s_branch S20
EVC12:
    s_call_b64 s[58:59], FIN1
    s_add_u32 s38, s38, s54
    s_branch P22
SLOW20:
    s_bitcmp1_b32 s41, 0
    s_cbranch_scc0 NL20
    s_waitcnt vmcnt(0)
    s_branch C20
NL20:
    s_bitset1_b32 s41, 0
    s_branch P20
XSYNC20:
    s_call_b64 s[58:59], SYNC
    s_cbranch_scc1 I20
    s_bitset0_b32 s41, 0
    s_branch S21
EV20:
    s_cmp_eq_u32 s42, 0
    s_cbranch_scc0 EVB20
    s_add_u32 s38, s38, s51
    s_branch P30
EVB20:
    s_cmp_eq_u32 s37, s39
    s_cbranch_scc1 EVC20
    s_waitcnt lgkmcnt(0)
    v_add_u32 v14, v12, v2
    v_add_u32 v15, v13, v2
    v_add_u32 v3, 64, v3
    buffer_load_dwordx4 v[24:27], v14, s[8:11], 0 offen sc1
    buffer_load_dwordx4 v[28:31], v15, s[8:11], 0 offen sc1
    ds_read_b64 v[12:13], v3
    s_add_u32 s37, s37, 1
    s_call_b64 s[58:59], FIN2
    s_add_u32 s38, s38, s55
    s_branch S31
EVC20:
    s_call_b64 s[58:59], FIN2
    s_add_u32 s38, s38, s55
    s_branch P30
SLOW21:
    s_bitcmp1_b32 s41, 1
    s_cbranch_scc0 NL21
    s_waitcnt vmcnt(0)
    s_branch C21
NL21:
    s_bitset1_b32 s41, 1
    s_branch P21
XSYNC21:
    s_call_b64 s[58:59], SYNC
    s_cbranch_scc1 I21
    s_bitset0_b32 s41, 1
    s_branch S22
EV21:
    s_cmp_eq_u32 s42, 0
    s_cbranch_scc0 EVB21
    s_add_u32 s38, s38, s51
    s_branch P31
EVB21:
    s_cmp_eq_u32 s37, s39
    s_cbranch_scc1 EVC21
    s_waitcnt lgkmcnt(0)
    v_add_u32 v14, v12, v2
    v_add_u32 v15, v13, v2
    v_add_u32 v3, 64, v3
    buffer_load_dwordx4 v[32:35], v14, s[8:11], 0 offen sc1
    buffer_load_dwordx4 v[36:39], v15, s[8:11], 0 offen sc1
    ds_read_b64 v[12:13], v3
    s_add_u32 s37, s37, 1
    s_call_b64 s[58:59], FIN2
    s_add_u32 s38, s38, s55
    s_branch S32
EVC21:
    s_call_b64 s[58:59], FIN2
    s_add_u32 s38, s38, s55
    s_branch P31
SLOW22:
    s_bitcmp1_b32 s41, 2
    s_cbranch_scc0 NL22
    s_waitcnt vmcnt(0)
    s_branch C22
NL22:
    s_bitset1_b32 s41, 2
    s_branch P22
XSYNC22:
    s_call_b64 s[58:59], SYNC
    s_cbranch_scc1 I22
    s_bitset0_b32 s41, 2
    s_branch S20
EV22:
    s_cmp_eq_u32 s42, 0
    s_cbranch_scc0 EVB22
    s_add_u32 s38, s38, s51
    s_branch P32
EVB22:
    s_cmp_eq_u32 s37, s39
    s_cbranch_scc1 EVC22
    s_waitcnt lgkmcnt(0)
    v_add_u32 v14, v12, v2
    v_add_u32 v15, v13, v2
    v_add_u32 v3, 64, v3
    buffer_load_dwordx4 v[40:43], v14, s[8:11], 0 offen sc1
    buffer_load_dwordx4 v[44:47], v15, s[8:11], 0 offen sc1
    ds_read_b64 v[12:13], v3
    s_add_u32 s37, s37, 1
    s_call_b64 s[58:59], FIN2
    s_add_u32 s38, s38, s55
    s_branch S30
EVC22:
    s_call_b64 s[58:59], FIN2
    s_add_u32 s38, s38, s55
    s_branch P32
SLOW30:
    s_bitcmp1_b32 s41, 0
    s_cbranch_scc0 NL30
    s_waitcnt vmcnt(0)
    s_branch C30
NL30:
    s_bitset1_b32 s41, 0
    s_branch P30
XSYNC30:
    s_call_b64 s[58:59], SYNC
    s_cbranch_scc1 I30
    s_bitset0_b32 s41, 0
    s_branch S31
EV30:
    s_cmp_eq_u32 s42, 0
    s_cbranch_scc0 EVB30
    s_xor_b32 s42, s42, 1
    s_add_u32 s38, s38, s79
    s_cmp_eq_u32 s48, 0
    s_cbranch_scc1 P10
    s_branch P00
EVB30:
    s_cmp_eq_u32 s37, s39
    s_cbranch_scc1 EVC30
    s_waitcnt lgkmcnt(0)
    v_add_u32 v14, v12, v2
    v_add_u32 v15, v13, v2
    v_add_u32 v3, 64, v3
    buffer_load_dwordx4 v[24:27], v14, s[8:11], 0 offen sc1
    buffer_load_dwordx4 v[28:31], v15, s[8:11], 0 offen sc1
    ds_read_b64 v[12:13], v3
    s_add_u32 s37, s37, 1
    s_call_b64 s[58:59], FIN3
    s_movk_i32 s69, 1
    s_branch HOPEND
EVC30:
    s_call_b64 s[58:59], FIN3
    s_cmp_eq_u32 s43, 7
    s_cbranch_scc1 ATT_ALL
    s_movk_i32 s69, 0
    s_branch HOPEND
SLOW31:
    s_bitcmp1_b32 s41, 1
    s_cbranch_scc0 NL31
    s_waitcnt vmcnt(0)
    s_branch C31
NL31:
    s_bitset1_b32 s41, 1
    s_branch P31
XSYNC31:
    s_call_b64 s[58:59], SYNC
    s_cbranch_scc1 I31
    s_bitset0_b32 s41, 1
    s_branch S32
EV31:
    s_cmp_eq_u32 s42, 0
    s_cbranch_scc0 EVB31
    s_xor_b32 s42, s42, 1
    s_add_u32 s38, s38, s79
    s_cmp_eq_u32 s48, 0
    s_cbranch_scc1 P11
    s_branch P01
EVB31:
    s_cmp_eq_u32 s37, s39
    s_cbranch_scc1 EVC31
    s_waitcnt lgkmcnt(0)
    v_add_u32 v14, v12, v2
    v_add_u32 v15, v13, v2
    v_add_u32 v3, 64, v3
    buffer_load_dwordx4 v[32:35], v14, s[8:11], 0 offen sc1
    buffer_load_dwordx4 v[36:39], v15, s[8:11], 0 offen sc1
    ds_read_b64 v[12:13], v3
    s_add_u32 s37, s37, 1
    s_call_b64 s[58:59], FIN3
    s_movk_i32 s69, 3
    s_branch HOPEND
EVC31:
    s_call_b64 s[58:59], FIN3
    s_cmp_eq_u32 s43, 7
    s_cbranch_scc1 ATT_ALL
    s_movk_i32 s69, 2
    s_branch HOPEND
SLOW32:
    s_bitcmp1_b32 s41, 2
    s_cbranch_scc0 NL32
    s_waitcnt vmcnt(0)
    s_branch C32
NL32:
    s_bitset1_b32 s41, 2
    s_branch P32
XSYNC32:
    s_call_b64 s[58:59], SYNC
    s_cbranch_scc1 I32
    s_bitset0_b32 s41, 2
    s_branch S30
EV32:
    s_cmp_eq_u32 s42, 0
    s_cbranch_scc0 EVB32
    s_xor_b32 s42, s42, 1
    s_add_u32 s38, s38, s79
    s_cmp_eq_u32 s48, 0
    s_cbranch_scc1 P12
    s_branch P02
EVB32:
    s_cmp_eq_u32 s37, s39
    s_cbranch_scc1 EVC32
    s_waitcnt lgkmcnt(0)
    v_add_u32 v14, v12, v2
    v_add_u32 v15, v13, v2
    v_add_u32 v3, 64, v3
    buffer_load_dwordx4 v[40:43], v14, s[8:11], 0 offen sc1
    buffer_load_dwordx4 v[44:47], v15, s[8:11], 0 offen sc1
    ds_read_b64 v[12:13], v3
    s_add_u32 s37, s37, 1
    s_call_b64 s[58:59], FIN3
    s_movk_i32 s69, 5
    s_branch HOPEND
EVC32:
    s_call_b64 s[58:59], FIN3
    s_cmp_eq_u32 s43, 7
    s_cbranch_scc1 ATT_ALL
    s_movk_i32 s69, 4
    s_branch HOPEND
HOPEND:
    s_cmp_eq_u32 s48, 0
    s_cbranch_scc1 HE0
    s_call_b64 s[58:59], FINS0
HE0:
    s_call_b64 s[58:59], FINS1
HE3:
    s_add_u32 s62, s43, 8
    v_mov_b32 v216, s62
    s_waitcnt vmcnt(0)
    ds_write_b32 v252, v216 offset:56
    s_call_b64 s[58:59], FINS2
    s_call_b64 s[58:59], FINS3
HE1:
    s_call_b64 s[58:59], WRAP
    s_cmp_eq_u32 s48, 0
    s_cbranch_scc1 HE2
    s_cmp_eq_u32 s69, 0
    s_cbranch_scc1 P00
    s_cmp_eq_u32 s69, 1
    s_cbranch_scc1 S01
    s_cmp_eq_u32 s69, 2
    s_cbranch_scc1 P01
    s_cmp_eq_u32 s69, 3
    s_cbranch_scc1 S02
    s_cmp_eq_u32 s69, 4
    s_cbranch_scc1 P02
    s_branch S00
HE2:
    s_cmp_eq_u32 s69, 0
    s_cbranch_scc1 P10
    s_cmp_eq_u32 s69, 1
    s_cbranch_scc1 S11
    s_cmp_eq_u32 s69, 2
    s_cbranch_scc1 P11
    s_cmp_eq_u32 s69, 3
    s_cbranch_scc1 S12
    s_cmp_eq_u32 s69, 4
    s_cbranch_scc1 P12
    s_branch S10
WRAP:
    s_add_u32 s43, s43, 1
    s_mov_b32 s42, 0
    s_add_u32 s38, s38, s78
    s_add_u32 s12, s12, 0x1000000
    s_addc_u32 s13, s13, 0
    v_add_u32 v5, 4, v5
    s_cmp_eq_u32 s43, 3
    s_cbranch_scc0 WRAP1
    v_lshlrev_b32 v16, 4, v1
    s_movk_i32 s62, 0
    buffer_load_dwordx4 v[64:67], v16, s[24:27], s62 offen offset:0 sc1
    buffer_load_dwordx4 v[68:71], v16, s[24:27], s62 offen offset:1024 sc1
    buffer_load_dwordx4 v[72:75], v16, s[24:27], s62 offen offset:2048 sc1
    buffer_load_dwordx4 v[76:79], v16, s[24:27], s62 offen offset:3072 sc1
    s_movk_i32 s62, 4096
    buffer_load_dwordx4 v[80:83], v16, s[24:27], s62 offen offset:0 sc1
    buffer_load_dwordx4 v[84:87], v16, s[24:27], s62 offen offset:1024 sc1
    buffer_load_dwordx4 v[88:91], v16, s[24:27], s62 offen offset:2048 sc1
    buffer_load_dwordx4 v[92:95], v16, s[24:27], s62 offen offset:3072 sc1
    s_movk_i32 s62, 8192
    buffer_load_dwordx4 v[96:99], v16, s[24:27], s62 offen offset:0 sc1
    buffer_load_dwordx4 v[100:103], v16, s[24:27], s62 offen offset:1024 sc1
    buffer_load_dwordx4 v[104:107], v16, s[24:27], s62 offen offset:2048 sc1
    buffer_load_dwordx4 v[108:111], v16, s[24:27], s62 offen offset:3072 sc1
    s_movk_i32 s62, 12288
    buffer_load_dwordx4 v[112:115], v16, s[24:27], s62 offen offset:0 sc1
    buffer_load_dwordx4 v[116:119], v16, s[24:27], s62 offen offset:1024 sc1
    buffer_load_dwordx4 v[120:123], v16, s[24:27], s62 offen offset:2048 sc1
    buffer_load_dwordx4 v[124:127], v16, s[24:27], s62 offen offset:3072 sc1
WRAP1:
    s_cmp_eq_u32 s43, 3
    s_cbranch_scc0 WRAP2
    s_call_b64 s[96:97], ATT_SETUP
WRAP2:
    s_setpc_b64 s[58:59]
SYNC:
    s_cmp_eq_u32 s45, 2
    s_cbranch_scc0 SY_S
    v_mov_b32 v249, 161712
    v_mov_b32 v250, s44
    ds_write_b32 v249, v250
    s_add_u32 s39, s39, 4
    s_sub_u32 s45, s45, 2
    s_cmp_eq_u32 s45, 0
    s_setpc_b64 s[58:59]
SY_S:
    s_lshl_b32 s63, s45, 2
    s_xor_b32 s63, s63, 4
    s_add_u32 s64, s44, s45
    s_cmp_eq_u32 s64, 8
    s_cbranch_scc1 SY_NO
    s_add_u32 s62, s63, 161696
    v_mov_b32 v249, s62
    ds_read_b32 v250, v249
    s_waitcnt lgkmcnt(0)
    v_readfirstlane_b32 s62, v250
    s_cmp_ge_u32 s62, s64
    s_cbranch_scc0 SY_FAIL
SY_OK:
    s_cmp_eq_u32 s45, 0
    s_cbranch_scc0 SY_WRAP
    s_add_u32 s39, s39, s47
    s_xor_b32 s45, s45, 1
    s_cmp_eq_u32 s45, 1
    s_setpc_b64 s[58:59]
SY_WRAP:
    v_mov_b32 v3, v0
    ds_read_b64 v[12:13], v0
    s_add_u32 s44, s44, 1
    s_add_u32 s8, s8, 0x1000000
    s_addc_u32 s9, s9, 0
    s_add_u32 s39, s39, s46
    s_sub_u32 s39, s39, 4
    s_mov_b32 s45, 2
    s_cmp_eq_u32 s45, s45
    s_setpc_b64 s[58:59]
SY_FAIL:
    s_bcnt1_i32_b32 s62, s41
    s_cmp_gt_u32 s62, 1
    s_cbranch_scc1 SY_NO
    s_add_u32 s57, s57, 1
    s_cmp_gt_u32 s57, 16777216
    s_cbranch_scc1 K_END
SY_NO:
    s_cmp_lg_u32 s45, s45
    s_setpc_b64 s[58:59]
FIN0:
    ds_read_b32 v220, v4 offset:2312
    s_cmp_lg_u32 s70, 0
    s_cbranch_scc1 OVF0
FINB0:
    s_nop 3
    v_permlane16_swap_b32 v128, v132
    v_permlane16_swap_b32 v129, v133
    v_permlane16_swap_b32 v130, v134
    v_permlane16_swap_b32 v131, v135
    s_cmp_eq_u32 s43, 7
    s_waitcnt lgkmcnt(0)
    v_pk_mul_f32 v[128:129], v[128:129], v[220:221] op_sel_hi:[1,0]
    v_pk_mul_f32 v[130:131], v[130:131], v[220:221] op_sel_hi:[1,0]
    v_pk_mul_f32 v[132:133], v[132:133], v[220:221] op_sel_hi:[1,0]
    v_pk_mul_f32 v[134:135], v[134:135], v[220:221] op_sel_hi:[1,0]
    s_cbranch_scc1 FINS0
    v_pk_mul_f32 v[16:17], v[128:129], v[220:221] op_sel_hi:[1,0]
    v_cvt_pk_bf16_f32 v20, v16, v17
    v_pk_mul_f32 v[18:19], v[130:131], v[220:221] op_sel_hi:[1,0]
    v_cvt_pk_bf16_f32 v21, v18, v19
    v_pk_mul_f32 v[16:17], v[132:133], v[220:221] op_sel_hi:[1,0]
    v_cvt_pk_bf16_f32 v22, v16, v17
    v_pk_mul_f32 v[18:19], v[134:135], v[220:221] op_sel_hi:[1,0]
    v_cvt_pk_bf16_f32 v23, v18, v19
    v_mov_b32 v216, s43
    ds_write_b128 v224, v[20:23] offset:18432
    ds_write_b32 v252, v216 offset:72
    s_setpc_b64 s[58:59]
FINS0:
    v_pk_add_f32 v[16:17], v[128:129], v[130:131]
    v_pk_mul_f32 v[18:19], v[128:129], v[128:129]
    v_pk_add_f32 v[16:17], v[16:17], v[132:133]
    v_pk_fma_f32 v[18:19], v[130:131], v[130:131], v[18:19]
    v_pk_add_f32 v[16:17], v[16:17], v[134:135]
    v_pk_fma_f32 v[18:19], v[132:133], v[132:133], v[18:19]
    v_add_f32 v248, v16, v17
    v_pk_fma_f32 v[18:19], v[134:135], v[134:135], v[18:19]
    v_add_f32 v249, v18, v19
    v_add_f32_dpp v248, v248, v248 quad_perm:[1,0,3,2] row_mask:0xf bank_mask:0xf
    s_nop 0
    v_add_f32_dpp v249, v249, v249 quad_perm:[1,0,3,2] row_mask:0xf bank_mask:0xf
    v_add_f32_dpp v248, v248, v248 quad_perm:[2,3,0,1] row_mask:0xf bank_mask:0xf
    s_nop 0
    v_add_f32_dpp v249, v249, v249 quad_perm:[2,3,0,1] row_mask:0xf bank_mask:0xf
    v_add_f32_dpp v248, v248, v248 row_half_mirror row_mask:0xf bank_mask:0xf
    s_nop 0
    v_add_f32_dpp v249, v249, v249 row_half_mirror row_mask:0xf bank_mask:0xf
    v_mul_f32 v220, 0x3c800000, v248
    v_cvt_pk_bf16_f32 v220, 0, v220
    v_pk_add_f32 v[128:129], v[128:129], v[220:221] op_sel_hi:[1,0] neg_lo:[0,1] neg_hi:[0,1]
    v_pk_add_f32 v[130:131], v[130:131], v[220:221] op_sel_hi:[1,0] neg_lo:[0,1] neg_hi:[0,1]
    v_pk_add_f32 v[132:133], v[132:133], v[220:221] op_sel_hi:[1,0] neg_lo:[0,1] neg_hi:[0,1]
    v_pk_add_f32 v[134:135], v[134:135], v[220:221] op_sel_hi:[1,0] neg_lo:[0,1] neg_hi:[0,1]
    v_cvt_pk_bf16_f32 v16, v128, v129
    v_cvt_pk_bf16_f32 v17, v130, v131
    v_cvt_pk_bf16_f32 v18, v132, v133
    v_cvt_pk_bf16_f32 v19, v134, v135
    v_mov_b64 v[128:129], 0
    v_mov_b64 v[130:131], 0
    v_mov_b64 v[132:133], 0
    v_mov_b64 v[134:135], 0
    v_mul_f32 v248, v248, v248
    v_fma_f32 v248, v249, s74, -v248
    v_max_f32 v248, 0, v248
    v_add_f32 v248, 0x3d27c5ac, v248
    v_rsq_f32 v248, v248
    v_lshrrev_b32 v220, 16, v220
    v_sub_u32 v248, v248, v220
    v_add_u32 v248, 0x8000, v248
    v_and_b32 v248, 0xffff0000, v248
    v_or_b32 v248, v248, v220
    ds_write_b32 v5, v248 offset:4608
    s_cmp_eq_u32 s43, 1
    s_cbranch_scc0 FH02
    v_xor_b32 v250, 128, v6
    s_add_u32 s62, s76, 25600
    v_add_u32 v250, s62, v250
    ds_write_b128 v250, v[16:19] offset:18432
    v_dot2_f32_bf16 v248, v160, s73, 0
    v_dot2_f32_bf16 v249, v160, v160, 0
    v_dot2_f32_bf16 v248, v161, s73, v248
    v_dot2_f32_bf16 v249, v161, v161, v249
    v_dot2_f32_bf16 v248, v162, s73, v248
    v_dot2_f32_bf16 v249, v162, v162, v249
    v_dot2_f32_bf16 v248, v163, s73, v248
    v_dot2_f32_bf16 v249, v163, v163, v249
    s_nop 1
    v_add_f32_dpp v248, v248, v248 quad_perm:[1,0,3,2] row_mask:0xf bank_mask:0xf
    v_add_f32_dpp v249, v249, v249 quad_perm:[1,0,3,2] row_mask:0xf bank_mask:0xf
    s_nop 0
    v_add_f32_dpp v248, v248, v248 quad_perm:[2,3,0,1] row_mask:0xf bank_mask:0xf
    v_add_f32_dpp v249, v249, v249 quad_perm:[2,3,0,1] row_mask:0xf bank_mask:0xf
    s_nop 0
    v_add_f32_dpp v248, v248, v248 row_half_mirror row_mask:0xf bank_mask:0xf
    v_add_f32_dpp v249, v249, v249 row_half_mirror row_mask:0xf bank_mask:0xf
    v_mul_f32 v220, 0x3c800000, v248
    v_cvt_pk_bf16_f32 v220, 0, v220
    v_mul_f32 v20, v248, v248
    v_mul_f32 v21, 4.0, v249
    v_cmp_gt_f32 vcc, v20, v21
    s_nop 1
    v_cndmask_b32 v220, 0, v220, vcc
    v_lshlrev_b32 v20, 16, v160
    v_and_b32 v21, 0xffff0000, v160
    v_sub_f32 v20, v20, v220
    v_sub_f32 v21, v21, v220
    v_cvt_pk_bf16_f32 v160, v20, v21
    v_lshlrev_b32 v20, 16, v161
    v_and_b32 v21, 0xffff0000, v161
    v_sub_f32 v20, v20, v220
    v_sub_f32 v21, v21, v220
    v_cvt_pk_bf16_f32 v161, v20, v21
    v_lshlrev_b32 v20, 16, v162
    v_and_b32 v21, 0xffff0000, v162
    v_sub_f32 v20, v20, v220
    v_sub_f32 v21, v21, v220
    v_cvt_pk_bf16_f32 v162, v20, v21
    v_lshlrev_b32 v20, 16, v163
    v_and_b32 v21, 0xffff0000, v163
    v_sub_f32 v20, v20, v220
    v_sub_f32 v21, v21, v220
    v_cvt_pk_bf16_f32 v163, v20, v21
    v_add_u32 v250, s76, v6
    ds_write_b128 v250, v[160:163] offset:18432
    v_subrev_u32 v5, 4, v5
    v_mul_f32 v248, v248, v248
    v_fma_f32 v248, v249, s74, -v248
    v_max_f32 v248, 0, v248
    v_add_f32 v248, 0x3d27c5ac, v248
    v_rsq_f32 v248, v248
    v_lshrrev_b32 v220, 16, v220
    v_sub_u32 v248, v248, v220
    v_add_u32 v248, 0x8000, v248
    v_and_b32 v248, 0xffff0000, v248
    v_or_b32 v248, v248, v220
    ds_write_b32 v5, v248 offset:4608
    v_add_u32 v5, 4, v5
    s_setpc_b64 s[58:59]
FH02:
    s_cmp_eq_u32 s43, 2
    s_cbranch_scc0 FH03
    v_xor_b32 v250, 32, v6
    s_add_u32 s62, s76, 51200
    v_add_u32 v250, s62, v250
    ds_write_b128 v250, v[16:19] offset:18432
    s_setpc_b64 s[58:59]
FH03:
    s_cmp_eq_u32 s43, 3
    s_cbranch_scc0 FH04
    v_xor_b32 v250, 160, v6
    v_add_u32 v250, s77, v250
    ds_write_b128 v250, v[16:19] offset:0
    s_setpc_b64 s[58:59]
FH04:
    s_cmp_eq_u32 s43, 4
    s_cbranch_scc0 FH05
    v_xor_b32 v250, 64, v6
    v_add_u32 v250, s77, v250
    ds_write_b128 v250, v[16:19] offset:4096
    s_setpc_b64 s[58:59]
FH05:
    s_cmp_eq_u32 s43, 5
    s_cbranch_scc0 FH06
    v_xor_b32 v250, 192, v6
    v_add_u32 v250, s77, v250
    ds_write_b128 v250, v[16:19] offset:8192
    s_setpc_b64 s[58:59]
FH06:
    s_cmp_eq_u32 s43, 6
    s_cbranch_scc0 FH07
    v_xor_b32 v250, 96, v6
    v_add_u32 v250, s77, v250
    ds_write_b128 v250, v[16:19] offset:12288
    s_setpc_b64 s[58:59]
FH07:
    v_xor_b32 v250, 224, v6
    v_add_u32 v250, s77, v250
    ds_write_b128 v250, v[16:19] offset:16384
    v_mov_b32 v216, 7
    ds_write_b32 v252, v216 offset:72
    s_setpc_b64 s[58:59]
OVF0:
    s_sub_u32 s84, s12, 0x1000000
    s_subb_u32 s85, s13, 0
    s_mov_b32 s86, 0x8a0000
    s_mov_b32 s87, 0x20000
    v_bfe_u32 v216, v1, 3, 2
    v_lshlrev_b32 v216, 3, v216
    s_lshl_b32 s62, s3, 6
    s_add_u32 s62, s62, 163264
    v_add_u32 v216, s62, v216
    ds_read_b64 v[248:249], v216
    ds_read_b64 v[250:251], v216 offset:32
    v_lshrrev_b32 v216, 5, v1
    s_waitcnt lgkmcnt(0)
OVL0:
    v_max_u32 v217, v249, v251
    v_cmp_lt_u32 vcc, v216, v217
    s_cbranch_vccz OVX0
    v_lshl_add_u32 v220, v216, 2, v248
    buffer_load_dword v220, v220, s[80:83], 0 offen sc1
    v_lshl_add_u32 v221, v216, 2, v250
    buffer_load_dword v221, v221, s[80:83], 0 offen sc1
    s_waitcnt vmcnt(0)
    v_add_u32 v220, v220, v2
    v_cmp_lt_u32 vcc, v216, v249
    s_nop 1
    v_cndmask_b32 v220, -1, v220, vcc
    buffer_load_dwordx4 v[16:19], v220, s[84:87], 0 offen sc1
    v_add_u32 v221, v221, v2
    v_cmp_lt_u32 vcc, v216, v251
    s_nop 1
    v_cndmask_b32 v221, -1, v221, vcc
    buffer_load_dwordx4 v[20:23], v221, s[84:87], 0 offen sc1
    v_add_u32 v216, 2, v216
    s_waitcnt vmcnt(0)
    v_mfma_f32_16x16x32_bf16 v[128:131], v[8:11], v[16:19], v[128:131]
    v_mfma_f32_16x16x32_bf16 v[132:135], v[8:11], v[20:23], v[132:135]
    s_nop 3
    s_branch OVL0
OVX0:
    ds_read_b32 v220, v4 offset:2312
    s_branch FINB0
FIN1:
    ds_read_b32 v220, v4 offset:8
    s_cmp_lg_u32 s70, 0
    s_cbranch_scc1 OVF1
FINB1:
    s_nop 3
    v_permlane16_swap_b32 v136, v140
    v_permlane16_swap_b32 v137, v141
    v_permlane16_swap_b32 v138, v142
    v_permlane16_swap_b32 v139, v143
    s_cmp_eq_u32 s43, 7
    s_waitcnt lgkmcnt(0)
    v_pk_mul_f32 v[136:137], v[136:137], v[220:221] op_sel_hi:[1,0]
    v_pk_mul_f32 v[138:139], v[138:139], v[220:221] op_sel_hi:[1,0]
    v_pk_mul_f32 v[140:141], v[140:141], v[220:221] op_sel_hi:[1,0]
    v_pk_mul_f32 v[142:143], v[142:143], v[220:221] op_sel_hi:[1,0]
    s_cbranch_scc1 FINS1
    v_pk_mul_f32 v[16:17], v[136:137], v[220:221] op_sel_hi:[1,0]
    v_cvt_pk_bf16_f32 v20, v16, v17
    v_pk_mul_f32 v[18:19], v[138:139], v[220:221] op_sel_hi:[1,0]
    v_cvt_pk_bf16_f32 v21, v18, v19
    v_pk_mul_f32 v[16:17], v[140:141], v[220:221] op_sel_hi:[1,0]
    v_cvt_pk_bf16_f32 v22, v16, v17
    v_pk_mul_f32 v[18:19], v[142:143], v[220:221] op_sel_hi:[1,0]
    v_cvt_pk_bf16_f32 v23, v18, v19
    v_mov_b32 v216, s43
    ds_write_b128 v224, v[20:23] offset:0
    ds_write_b32 v252, v216 offset:0
    s_setpc_b64 s[58:59]
FINS1:
    v_pk_add_f32 v[16:17], v[136:137], v[138:139]
    v_pk_mul_f32 v[18:19], v[136:137], v[136:137]
    v_pk_add_f32 v[16:17], v[16:17], v[140:141]
    v_pk_fma_f32 v[18:19], v[138:139], v[138:139], v[18:19]
    v_pk_add_f32 v[16:17], v[16:17], v[142:143]
    v_pk_fma_f32 v[18:19], v[140:141], v[140:141], v[18:19]
    v_add_f32 v248, v16, v17
    v_pk_fma_f32 v[18:19], v[142:143], v[142:143], v[18:19]
    v_add_f32 v249, v18, v19
    v_add_f32_dpp v248, v248, v248 quad_perm:[1,0,3,2] row_mask:0xf bank_mask:0xf
    s_nop 0
    v_add_f32_dpp v249, v249, v249 quad_perm:[1,0,3,2] row_mask:0xf bank_mask:0xf
    v_add_f32_dpp v248, v248, v248 quad_perm:[2,3,0,1] row_mask:0xf bank_mask:0xf
    s_nop 0
    v_add_f32_dpp v249, v249, v249 quad_perm:[2,3,0,1] row_mask:0xf bank_mask:0xf
    v_add_f32_dpp v248, v248, v248 row_half_mirror row_mask:0xf bank_mask:0xf
    s_nop 0
    v_add_f32_dpp v249, v249, v249 row_half_mirror row_mask:0xf bank_mask:0xf
    v_mul_f32 v220, 0x3c800000, v248
    v_cvt_pk_bf16_f32 v220, 0, v220
    v_pk_add_f32 v[136:137], v[136:137], v[220:221] op_sel_hi:[1,0] neg_lo:[0,1] neg_hi:[0,1]
    v_pk_add_f32 v[138:139], v[138:139], v[220:221] op_sel_hi:[1,0] neg_lo:[0,1] neg_hi:[0,1]
    v_pk_add_f32 v[140:141], v[140:141], v[220:221] op_sel_hi:[1,0] neg_lo:[0,1] neg_hi:[0,1]
    v_pk_add_f32 v[142:143], v[142:143], v[220:221] op_sel_hi:[1,0] neg_lo:[0,1] neg_hi:[0,1]
    v_cvt_pk_bf16_f32 v16, v136, v137
    v_cvt_pk_bf16_f32 v17, v138, v139
    v_cvt_pk_bf16_f32 v18, v140, v141
    v_cvt_pk_bf16_f32 v19, v142, v143
    v_mov_b64 v[136:137], 0
    v_mov_b64 v[138:139], 0
    v_mov_b64 v[140:141], 0
    v_mov_b64 v[142:143], 0
    v_mul_f32 v248, v248, v248
    v_fma_f32 v248, v249, s74, -v248
    v_max_f32 v248, 0, v248
    v_add_f32 v248, 0x3d27c5ac, v248
    v_rsq_f32 v248, v248
    v_lshrrev_b32 v220, 16, v220
    v_sub_u32 v248, v248, v220
    v_add_u32 v248, 0x8000, v248
    v_and_b32 v248, 0xffff0000, v248
    v_or_b32 v248, v248, v220
    ds_write_b32 v5, v248 offset:0
    s_cmp_eq_u32 s43, 1
    s_cbranch_scc0 FH12
    v_xor_b32 v250, 128, v6
    s_add_u32 s62, s76, 25600
    v_add_u32 v250, s62, v250
    ds_write_b128 v250, v[16:19] offset:0
    v_dot2_f32_bf16 v248, v164, s73, 0
    v_dot2_f32_bf16 v249, v164, v164, 0
    v_dot2_f32_bf16 v248, v165, s73, v248
    v_dot2_f32_bf16 v249, v165, v165, v249
    v_dot2_f32_bf16 v248, v166, s73, v248
    v_dot2_f32_bf16 v249, v166, v166, v249
    v_dot2_f32_bf16 v248, v167, s73, v248
    v_dot2_f32_bf16 v249, v167, v167, v249
    s_nop 1
    v_add_f32_dpp v248, v248, v248 quad_perm:[1,0,3,2] row_mask:0xf bank_mask:0xf
    v_add_f32_dpp v249, v249, v249 quad_perm:[1,0,3,2] row_mask:0xf bank_mask:0xf
    s_nop 0
    v_add_f32_dpp v248, v248, v248 quad_perm:[2,3,0,1] row_mask:0xf bank_mask:0xf
    v_add_f32_dpp v249, v249, v249 quad_perm:[2,3,0,1] row_mask:0xf bank_mask:0xf
    s_nop 0
    v_add_f32_dpp v248, v248, v248 row_half_mirror row_mask:0xf bank_mask:0xf
    v_add_f32_dpp v249, v249, v249 row_half_mirror row_mask:0xf bank_mask:0xf
    v_mul_f32 v220, 0x3c800000, v248
    v_cvt_pk_bf16_f32 v220, 0, v220
    v_mul_f32 v20, v248, v248
    v_mul_f32 v21, 4.0, v249
    v_cmp_gt_f32 vcc, v20, v21
    s_nop 1
    v_cndmask_b32 v220, 0, v220, vcc
    v_lshlrev_b32 v20, 16, v164
    v_and_b32 v21, 0xffff0000, v164
    v_sub_f32 v20, v20, v220
    v_sub_f32 v21, v21, v220
    v_cvt_pk_bf16_f32 v164, v20, v21
    v_lshlrev_b32 v20, 16, v165
    v_and_b32 v21, 0xffff0000, v165
    v_sub_f32 v20, v20, v220
    v_sub_f32 v21, v21, v220
    v_cvt_pk_bf16_f32 v165, v20, v21
    v_lshlrev_b32 v20, 16, v166
    v_and_b32 v21, 0xffff0000, v166
    v_sub_f32 v20, v20, v220
    v_sub_f32 v21, v21, v220
    v_cvt_pk_bf16_f32 v166, v20, v21
    v_lshlrev_b32 v20, 16, v167
    v_and_b32 v21, 0xffff0000, v167
    v_sub_f32 v20, v20, v220
    v_sub_f32 v21, v21, v220
    v_cvt_pk_bf16_f32 v167, v20, v21
    v_add_u32 v250, s76, v6
    ds_write_b128 v250, v[164:167] offset:0
    v_subrev_u32 v5, 4, v5
    v_mul_f32 v248, v248, v248
    v_fma_f32 v248, v249, s74, -v248
    v_max_f32 v248, 0, v248
    v_add_f32 v248, 0x3d27c5ac, v248
    v_rsq_f32 v248, v248
    v_lshrrev_b32 v220, 16, v220
    v_sub_u32 v248, v248, v220
    v_add_u32 v248, 0x8000, v248
    v_and_b32 v248, 0xffff0000, v248
    v_or_b32 v248, v248, v220
    ds_write_b32 v5, v248 offset:0
    v_add_u32 v5, 4, v5
    s_setpc_b64 s[58:59]
FH12:
    s_cmp_eq_u32 s43, 2
    s_cbranch_scc0 FH13
    v_xor_b32 v250, 32, v6
    s_add_u32 s62, s76, 51200
    v_add_u32 v250, s62, v250
    ds_write_b128 v250, v[16:19] offset:0
    s_setpc_b64 s[58:59]
FH13:
    s_cmp_eq_u32 s43, 3
    s_cbranch_scc0 FH14
    v_mov_b64 v[160:161], v[16:17]
    v_mov_b64 v[162:163], v[18:19]
    s_setpc_b64 s[58:59]
FH14:
    s_cmp_eq_u32 s43, 4
    s_cbranch_scc0 FH15
    v_mov_b64 v[164:165], v[16:17]
    v_mov_b64 v[166:167], v[18:19]
    s_setpc_b64 s[58:59]
FH15:
    s_cmp_eq_u32 s43, 5
    s_cbranch_scc0 FH16
    v_mov_b64 v[168:169], v[16:17]
    v_mov_b64 v[170:171], v[18:19]
    s_setpc_b64 s[58:59]
FH16:
    s_cmp_eq_u32 s43, 6
    s_cbranch_scc0 FH17
    v_mov_b64 v[172:173], v[16:17]
    v_mov_b64 v[174:175], v[18:19]
    s_setpc_b64 s[58:59]
FH17:
    v_mov_b64 v[136:137], v[16:17]
    v_mov_b64 v[138:139], v[18:19]
    s_setpc_b64 s[58:59]
OVF1:
    s_sub_u32 s84, s12, 0x1000000
    s_subb_u32 s85, s13, 0
    s_mov_b32 s86, 0x8a0000
    s_mov_b32 s87, 0x20000
    v_bfe_u32 v216, v1, 3, 2
    v_lshlrev_b32 v216, 3, v216
    s_lshl_b32 s62, s3, 6
    s_add_u32 s62, s62, 162112
    v_add_u32 v216, s62, v216
    ds_read_b64 v[248:249], v216
    ds_read_b64 v[250:251], v216 offset:32
    v_lshrrev_b32 v216, 5, v1
    s_waitcnt lgkmcnt(0)
OVL1:
    v_max_u32 v217, v249, v251
    v_cmp_lt_u32 vcc, v216, v217
    s_cbranch_vccz OVX1
    v_lshl_add_u32 v220, v216, 2, v248
    buffer_load_dword v220, v220, s[80:83], 0 offen sc1
    v_lshl_add_u32 v221, v216, 2, v250
    buffer_load_dword v221, v221, s[80:83], 0 offen sc1
    s_waitcnt vmcnt(0)
    v_add_u32 v220, v220, v2
    v_cmp_lt_u32 vcc, v216, v249
    s_nop 1
    v_cndmask_b32 v220, -1, v220, vcc
    buffer_load_dwordx4 v[16:19], v220, s[84:87], 0 offen sc1
    v_add_u32 v221, v221, v2
    v_cmp_lt_u32 vcc, v216, v251
    s_nop 1
    v_cndmask_b32 v221, -1, v221, vcc
    buffer_load_dwordx4 v[20:23], v221, s[84:87], 0 offen sc1
    v_add_u32 v216, 2, v216
    s_waitcnt vmcnt(0)
    v_mfma_f32_16x16x32_bf16 v[136:139], v[8:11], v[16:19], v[136:139]
    v_mfma_f32_16x16x32_bf16 v[140:143], v[8:11], v[20:23], v[140:143]
    s_nop 3
    s_branch OVL1
OVX1:
    ds_read_b32 v220, v4 offset:8
    s_branch FINB1
FIN2:
    ds_read_b32 v220, v4 offset:904
    s_cmp_lg_u32 s70, 0
    s_cbranch_scc1 OVF2
FINB2:
    s_nop 3
    v_permlane16_swap_b32 v144, v148
    v_permlane16_swap_b32 v145, v149
    v_permlane16_swap_b32 v146, v150
    v_permlane16_swap_b32 v147, v151
    s_cmp_eq_u32 s43, 7
    s_waitcnt lgkmcnt(0)
    v_pk_mul_f32 v[144:145], v[144:145], v[220:221] op_sel_hi:[1,0]
    v_pk_mul_f32 v[146:147], v[146:147], v[220:221] op_sel_hi:[1,0]
    v_pk_mul_f32 v[148:149], v[148:149], v[220:221] op_sel_hi:[1,0]
    v_pk_mul_f32 v[150:151], v[150:151], v[220:221] op_sel_hi:[1,0]
    s_cbranch_scc1 FINS2
    v_pk_mul_f32 v[16:17], v[144:145], v[220:221] op_sel_hi:[1,0]
    v_cvt_pk_bf16_f32 v20, v16, v17
    v_pk_mul_f32 v[18:19], v[146:147], v[220:221] op_sel_hi:[1,0]
    v_cvt_pk_bf16_f32 v21, v18, v19
    v_pk_mul_f32 v[16:17], v[148:149], v[220:221] op_sel_hi:[1,0]
    v_cvt_pk_bf16_f32 v22, v16, v17
    v_pk_mul_f32 v[18:19], v[150:151], v[220:221] op_sel_hi:[1,0]
    v_cvt_pk_bf16_f32 v23, v18, v19
    v_mov_b32 v216, s43
    ds_write_b128 v224, v[20:23] offset:7168
    ds_write_b32 v252, v216 offset:28
    s_setpc_b64 s[58:59]
FINS2:
    v_pk_add_f32 v[16:17], v[144:145], v[146:147]
    v_pk_mul_f32 v[18:19], v[144:145], v[144:145]
    v_pk_add_f32 v[16:17], v[16:17], v[148:149]
    v_pk_fma_f32 v[18:19], v[146:147], v[146:147], v[18:19]
    v_pk_add_f32 v[16:17], v[16:17], v[150:151]
    v_pk_fma_f32 v[18:19], v[148:149], v[148:149], v[18:19]
    v_add_f32 v248, v16, v17
    v_pk_fma_f32 v[18:19], v[150:151], v[150:151], v[18:19]
    v_add_f32 v249, v18, v19
    v_add_f32_dpp v248, v248, v248 quad_perm:[1,0,3,2] row_mask:0xf bank_mask:0xf
    s_nop 0
    v_add_f32_dpp v249, v249, v249 quad_perm:[1,0,3,2] row_mask:0xf bank_mask:0xf
    v_add_f32_dpp v248, v248, v248 quad_perm:[2,3,0,1] row_mask:0xf bank_mask:0xf
    s_nop 0
    v_add_f32_dpp v249, v249, v249 quad_perm:[2,3,0,1] row_mask:0xf bank_mask:0xf
    v_add_f32_dpp v248, v248, v248 row_half_mirror row_mask:0xf bank_mask:0xf
    s_nop 0
    v_add_f32_dpp v249, v249, v249 row_half_mirror row_mask:0xf bank_mask:0xf
    v_mul_f32 v220, 0x3c800000, v248
    v_cvt_pk_bf16_f32 v220, 0, v220
    v_pk_add_f32 v[144:145], v[144:145], v[220:221] op_sel_hi:[1,0] neg_lo:[0,1] neg_hi:[0,1]
    v_pk_add_f32 v[146:147], v[146:147], v[220:221] op_sel_hi:[1,0] neg_lo:[0,1] neg_hi:[0,1]
    v_pk_add_f32 v[148:149], v[148:149], v[220:221] op_sel_hi:[1,0] neg_lo:[0,1] neg_hi:[0,1]
    v_pk_add_f32 v[150:151], v[150:151], v[220:221] op_sel_hi:[1,0] neg_lo:[0,1] neg_hi:[0,1]
    v_cvt_pk_bf16_f32 v16, v144, v145
    v_cvt_pk_bf16_f32 v17, v146, v147
    v_cvt_pk_bf16_f32 v18, v148, v149
    v_cvt_pk_bf16_f32 v19, v150, v151
    v_mov_b64 v[144:145], 0
    v_mov_b64 v[146:147], 0
    v_mov_b64 v[148:149], 0
    v_mov_b64 v[150:151], 0
    v_mul_f32 v248, v248, v248
    v_fma_f32 v248, v249, s74, -v248
    v_max_f32 v248, 0, v248
    v_add_f32 v248, 0x3d27c5ac, v248
    v_rsq_f32 v248, v248
    v_lshrrev_b32 v220, 16, v220
    v_sub_u32 v248, v248, v220
    v_add_u32 v248, 0x8000, v248
    v_and_b32 v248, 0xffff0000, v248
    v_or_b32 v248, v248, v220
    ds_write_b32 v5, v248 offset:1792
    s_cmp_eq_u32 s43, 1
    s_cbranch_scc0 FH22
    v_xor_b32 v250, 128, v6
    s_add_u32 s62, s76, 25600
    v_add_u32 v250, s62, v250
    ds_write_b128 v250, v[16:19] offset:7168
    v_dot2_f32_bf16 v248, v168, s73, 0
    v_dot2_f32_bf16 v249, v168, v168, 0
    v_dot2_f32_bf16 v248, v169, s73, v248
    v_dot2_f32_bf16 v249, v169, v169, v249
    v_dot2_f32_bf16 v248, v170, s73, v248
    v_dot2_f32_bf16 v249, v170, v170, v249
    v_dot2_f32_bf16 v248, v171, s73, v248
    v_dot2_f32_bf16 v249, v171, v171, v249
    s_nop 1
    v_add_f32_dpp v248, v248, v248 quad_perm:[1,0,3,2] row_mask:0xf bank_mask:0xf
    v_add_f32_dpp v249, v249, v249 quad_perm:[1,0,3,2] row_mask:0xf bank_mask:0xf
    s_nop 0
    v_add_f32_dpp v248, v248, v248 quad_perm:[2,3,0,1] row_mask:0xf bank_mask:0xf
    v_add_f32_dpp v249, v249, v249 quad_perm:[2,3,0,1] row_mask:0xf bank_mask:0xf
    s_nop 0
    v_add_f32_dpp v248, v248, v248 row_half_mirror row_mask:0xf bank_mask:0xf
    v_add_f32_dpp v249, v249, v249 row_half_mirror row_mask:0xf bank_mask:0xf
    v_mul_f32 v220, 0x3c800000, v248
    v_cvt_pk_bf16_f32 v220, 0, v220
    v_mul_f32 v20, v248, v248
    v_mul_f32 v21, 4.0, v249
    v_cmp_gt_f32 vcc, v20, v21
    s_nop 1
    v_cndmask_b32 v220, 0, v220, vcc
    v_lshlrev_b32 v20, 16, v168
    v_and_b32 v21, 0xffff0000, v168
    v_sub_f32 v20, v20, v220
    v_sub_f32 v21, v21, v220
    v_cvt_pk_bf16_f32 v168, v20, v21
    v_lshlrev_b32 v20, 16, v169
    v_and_b32 v21, 0xffff0000, v169
    v_sub_f32 v20, v20, v220
    v_sub_f32 v21, v21, v220
    v_cvt_pk_bf16_f32 v169, v20, v21
    v_lshlrev_b32 v20, 16, v170
    v_and_b32 v21, 0xffff0000, v170
    v_sub_f32 v20, v20, v220
    v_sub_f32 v21, v21, v220
    v_cvt_pk_bf16_f32 v170, v20, v21
    v_lshlrev_b32 v20, 16, v171
    v_and_b32 v21, 0xffff0000, v171
    v_sub_f32 v20, v20, v220
    v_sub_f32 v21, v21, v220
    v_cvt_pk_bf16_f32 v171, v20, v21
    v_add_u32 v250, s76, v6
    ds_write_b128 v250, v[168:171] offset:7168
    v_subrev_u32 v5, 4, v5
    v_mul_f32 v248, v248, v248
    v_fma_f32 v248, v249, s74, -v248
    v_max_f32 v248, 0, v248
    v_add_f32 v248, 0x3d27c5ac, v248
    v_rsq_f32 v248, v248
    v_lshrrev_b32 v220, 16, v220
    v_sub_u32 v248, v248, v220
    v_add_u32 v248, 0x8000, v248
    v_and_b32 v248, 0xffff0000, v248
    v_or_b32 v248, v248, v220
    ds_write_b32 v5, v248 offset:1792
    v_add_u32 v5, 4, v5
    s_setpc_b64 s[58:59]
FH22:
    s_cmp_eq_u32 s43, 2
    s_cbranch_scc0 FH23
    v_xor_b32 v250, 32, v6
    s_add_u32 s62, s76, 51200
    v_add_u32 v250, s62, v250
    ds_write_b128 v250, v[16:19] offset:7168
    s_setpc_b64 s[58:59]
FH23:
    s_cmp_eq_u32 s43, 3
    s_cbranch_scc0 FH24
    v_mov_b64 v[176:177], v[16:17]
    v_mov_b64 v[178:179], v[18:19]
    s_setpc_b64 s[58:59]
FH24:
    s_cmp_eq_u32 s43, 4
    s_cbranch_scc0 FH25
    v_mov_b64 v[180:181], v[16:17]
    v_mov_b64 v[182:183], v[18:19]
    s_setpc_b64 s[58:59]
FH25:
    s_cmp_eq_u32 s43, 5
    s_cbranch_scc0 FH26
    v_mov_b64 v[184:185], v[16:17]
    v_mov_b64 v[186:187], v[18:19]
    s_setpc_b64 s[58:59]
FH26:
    s_cmp_eq_u32 s43, 6
    s_cbranch_scc0 FH27
    v_mov_b64 v[188:189], v[16:17]
    v_mov_b64 v[190:191], v[18:19]
    s_setpc_b64 s[58:59]
FH27:
    v_mov_b64 v[144:145], v[16:17]
    v_mov_b64 v[146:147], v[18:19]
    s_setpc_b64 s[58:59]
OVF2:
    s_sub_u32 s84, s12, 0x1000000
    s_subb_u32 s85, s13, 0
    s_mov_b32 s86, 0x8a0000
    s_mov_b32 s87, 0x20000
    v_bfe_u32 v216, v1, 3, 2
    v_lshlrev_b32 v216, 3, v216
    s_lshl_b32 s62, s3, 6
    s_add_u32 s62, s62, 162560
    v_add_u32 v216, s62, v216
    ds_read_b64 v[248:249], v216
    ds_read_b64 v[250:251], v216 offset:32
    v_lshrrev_b32 v216, 5, v1
    s_waitcnt lgkmcnt(0)
OVL2:
    v_max_u32 v217, v249, v251
    v_cmp_lt_u32 vcc, v216, v217
    s_cbranch_vccz OVX2
    v_lshl_add_u32 v220, v216, 2, v248
    buffer_load_dword v220, v220, s[80:83], 0 offen sc1
    v_lshl_add_u32 v221, v216, 2, v250
    buffer_load_dword v221, v221, s[80:83], 0 offen sc1
    s_waitcnt vmcnt(0)
    v_add_u32 v220, v220, v2
    v_cmp_lt_u32 vcc, v216, v249
    s_nop 1
    v_cndmask_b32 v220, -1, v220, vcc
    buffer_load_dwordx4 v[16:19], v220, s[84:87], 0 offen sc1
    v_add_u32 v221, v221, v2
    v_cmp_lt_u32 vcc, v216, v251
    s_nop 1
    v_cndmask_b32 v221, -1, v221, vcc
    buffer_load_dwordx4 v[20:23], v221, s[84:87], 0 offen sc1
    v_add_u32 v216, 2, v216
    s_waitcnt vmcnt(0)
    v_mfma_f32_16x16x32_bf16 v[144:147], v[8:11], v[16:19], v[144:147]
    v_mfma_f32_16x16x32_bf16 v[148:151], v[8:11], v[20:23], v[148:151]
    s_nop 3
    s_branch OVL2
OVX2:
    ds_read_b32 v220, v4 offset:904
    s_branch FINB2
FIN3:
    ds_read_b32 v220, v4 offset:1800
    s_cmp_lg_u32 s70, 0
    s_cbranch_scc1 OVF3
FINB3:
    ds_read_b64 v[248:249], v4 offset:1792
    s_nop 3
    v_permlane16_swap_b32 v152, v156
    v_permlane16_swap_b32 v153, v157
    v_permlane16_swap_b32 v154, v158
    v_permlane16_swap_b32 v155, v159
    s_cmp_eq_u32 s43, 7
    s_waitcnt lgkmcnt(0)
    v_pk_mul_f32 v[152:153], v[152:153], v[220:221] op_sel_hi:[1,0]
    v_pk_mul_f32 v[154:155], v[154:155], v[220:221] op_sel_hi:[1,0]
    v_pk_mul_f32 v[156:157], v[156:157], v[220:221] op_sel_hi:[1,0]
    v_pk_mul_f32 v[158:159], v[158:159], v[220:221] op_sel_hi:[1,0]
    s_cbranch_scc1 FINS3
    v_pk_mul_f32 v[16:17], v[152:153], v[220:221] op_sel_hi:[1,0]
    v_cvt_pk_bf16_f32 v20, v16, v17
    v_pk_mul_f32 v[18:19], v[154:155], v[220:221] op_sel_hi:[1,0]
    v_cvt_pk_bf16_f32 v21, v18, v19
    v_pk_mul_f32 v[16:17], v[156:157], v[220:221] op_sel_hi:[1,0]
    v_cvt_pk_bf16_f32 v22, v16, v17
    v_pk_mul_f32 v[18:19], v[158:159], v[220:221] op_sel_hi:[1,0]
    v_cvt_pk_bf16_f32 v23, v18, v19
    v_add_u32 v248, v248, v2
    v_add_u32 v249, v249, v2
    buffer_store_dwordx4 v[20:23], v248, s[12:15], 0 offen sc1
    buffer_store_dwordx4 v[20:23], v249, s[12:15], 0 offen sc1
    s_setpc_b64 s[58:59]
FINS3:
    v_pk_add_f32 v[16:17], v[152:153], v[154:155]
    v_pk_mul_f32 v[18:19], v[152:153], v[152:153]
    v_pk_add_f32 v[16:17], v[16:17], v[156:157]
    v_pk_fma_f32 v[18:19], v[154:155], v[154:155], v[18:19]
    v_pk_add_f32 v[16:17], v[16:17], v[158:159]
    v_pk_fma_f32 v[18:19], v[156:157], v[156:157], v[18:19]
    v_add_f32 v248, v16, v17
    v_pk_fma_f32 v[18:19], v[158:159], v[158:159], v[18:19]
    v_add_f32 v249, v18, v19
    v_add_f32_dpp v248, v248, v248 quad_perm:[1,0,3,2] row_mask:0xf bank_mask:0xf
    s_nop 0
    v_add_f32_dpp v249, v249, v249 quad_perm:[1,0,3,2] row_mask:0xf bank_mask:0xf
    v_add_f32_dpp v248, v248, v248 quad_perm:[2,3,0,1] row_mask:0xf bank_mask:0xf
    s_nop 0
    v_add_f32_dpp v249, v249, v249 quad_perm:[2,3,0,1] row_mask:0xf bank_mask:0xf
    v_add_f32_dpp v248, v248, v248 row_half_mirror row_mask:0xf bank_mask:0xf
    s_nop 0
    v_add_f32_dpp v249, v249, v249 row_half_mirror row_mask:0xf bank_mask:0xf
    v_mul_f32 v220, 0x3c800000, v248
    v_cvt_pk_bf16_f32 v220, 0, v220
    v_pk_add_f32 v[152:153], v[152:153], v[220:221] op_sel_hi:[1,0] neg_lo:[0,1] neg_hi:[0,1]
    v_pk_add_f32 v[154:155], v[154:155], v[220:221] op_sel_hi:[1,0] neg_lo:[0,1] neg_hi:[0,1]
    v_pk_add_f32 v[156:157], v[156:157], v[220:221] op_sel_hi:[1,0] neg_lo:[0,1] neg_hi:[0,1]
    v_pk_add_f32 v[158:159], v[158:159], v[220:221] op_sel_hi:[1,0] neg_lo:[0,1] neg_hi:[0,1]
    v_cvt_pk_bf16_f32 v16, v152, v153
    v_cvt_pk_bf16_f32 v17, v154, v155
    v_cvt_pk_bf16_f32 v18, v156, v157
    v_cvt_pk_bf16_f32 v19, v158, v159
    v_mov_b64 v[152:153], 0
    v_mov_b64 v[154:155], 0
    v_mov_b64 v[156:157], 0
    v_mov_b64 v[158:159], 0
    v_mul_f32 v248, v248, v248
    v_fma_f32 v248, v249, s74, -v248
    v_max_f32 v248, 0, v248
    v_add_f32 v248, 0x3d27c5ac, v248
    v_rsq_f32 v248, v248
    v_lshrrev_b32 v220, 16, v220
    v_sub_u32 v248, v248, v220
    v_add_u32 v248, 0x8000, v248
    v_and_b32 v248, 0xffff0000, v248
    v_or_b32 v248, v248, v220
    ds_write_b32 v5, v248 offset:3584
    s_cmp_eq_u32 s43, 1
    s_cbranch_scc0 FH32
    v_xor_b32 v250, 128, v6
    s_add_u32 s62, s76, 25600
    v_add_u32 v250, s62, v250
    ds_write_b128 v250, v[16:19] offset:14336
    v_dot2_f32_bf16 v248, v172, s73, 0
    v_dot2_f32_bf16 v249, v172, v172, 0
    v_dot2_f32_bf16 v248, v173, s73, v248
    v_dot2_f32_bf16 v249, v173, v173, v249
    v_dot2_f32_bf16 v248, v174, s73, v248
    v_dot2_f32_bf16 v249, v174, v174, v249
    v_dot2_f32_bf16 v248, v175, s73, v248
    v_dot2_f32_bf16 v249, v175, v175, v249
    s_nop 1
    v_add_f32_dpp v248, v248, v248 quad_perm:[1,0,3,2] row_mask:0xf bank_mask:0xf
    v_add_f32_dpp v249, v249, v249 quad_perm:[1,0,3,2] row_mask:0xf bank_mask:0xf
    s_nop 0
    v_add_f32_dpp v248, v248, v248 quad_perm:[2,3,0,1] row_mask:0xf bank_mask:0xf
    v_add_f32_dpp v249, v249, v249 quad_perm:[2,3,0,1] row_mask:0xf bank_mask:0xf
    s_nop 0
    v_add_f32_dpp v248, v248, v248 row_half_mirror row_mask:0xf bank_mask:0xf
    v_add_f32_dpp v249, v249, v249 row_half_mirror row_mask:0xf bank_mask:0xf
    v_mul_f32 v220, 0x3c800000, v248
    v_cvt_pk_bf16_f32 v220, 0, v220
    v_mul_f32 v20, v248, v248
    v_mul_f32 v21, 4.0, v249
    v_cmp_gt_f32 vcc, v20, v21
    s_nop 1
    v_cndmask_b32 v220, 0, v220, vcc
    v_lshlrev_b32 v20, 16, v172
    v_and_b32 v21, 0xffff0000, v172
    v_sub_f32 v20, v20, v220
    v_sub_f32 v21, v21, v220
    v_cvt_pk_bf16_f32 v172, v20, v21
    v_lshlrev_b32 v20, 16, v173
    v_and_b32 v21, 0xffff0000, v173
    v_sub_f32 v20, v20, v220
    v_sub_f32 v21, v21, v220
    v_cvt_pk_bf16_f32 v173, v20, v21
    v_lshlrev_b32 v20, 16, v174
    v_and_b32 v21, 0xffff0000, v174
    v_sub_f32 v20, v20, v220
    v_sub_f32 v21, v21, v220
    v_cvt_pk_bf16_f32 v174, v20, v21
    v_lshlrev_b32 v20, 16, v175
    v_and_b32 v21, 0xffff0000, v175
    v_sub_f32 v20, v20, v220
    v_sub_f32 v21, v21, v220
    v_cvt_pk_bf16_f32 v175, v20, v21
    v_add_u32 v250, s76, v6
    ds_write_b128 v250, v[172:175] offset:14336
    v_subrev_u32 v5, 4, v5
    v_mul_f32 v248, v248, v248
    v_fma_f32 v248, v249, s74, -v248
    v_max_f32 v248, 0, v248
    v_add_f32 v248, 0x3d27c5ac, v248
    v_rsq_f32 v248, v248
    v_lshrrev_b32 v220, 16, v220
    v_sub_u32 v248, v248, v220
    v_add_u32 v248, 0x8000, v248
    v_and_b32 v248, 0xffff0000, v248
    v_or_b32 v248, v248, v220
    ds_write_b32 v5, v248 offset:3584
    v_add_u32 v5, 4, v5
    s_setpc_b64 s[58:59]
FH32:
    s_cmp_eq_u32 s43, 2
    s_cbranch_scc0 FH33
    v_xor_b32 v250, 32, v6
    s_add_u32 s62, s76, 51200
    v_add_u32 v250, s62, v250
    ds_write_b128 v250, v[16:19] offset:14336
    s_setpc_b64 s[58:59]
FH33:
    s_cmp_eq_u32 s43, 3
    s_cbranch_scc0 FH34
    v_mov_b64 v[192:193], v[16:17]
    v_mov_b64 v[194:195], v[18:19]
    s_setpc_b64 s[58:59]
FH34:
    s_cmp_eq_u32 s43, 4
    s_cbranch_scc0 FH35
    v_mov_b64 v[196:197], v[16:17]
    v_mov_b64 v[198:199], v[18:19]
    s_setpc_b64 s[58:59]
FH35:
    s_cmp_eq_u32 s43, 5
    s_cbranch_scc0 FH36
    v_mov_b64 v[200:201], v[16:17]
    v_mov_b64 v[202:203], v[18:19]
    s_setpc_b64 s[58:59]
FH36:
    s_cmp_eq_u32 s43, 6
    s_cbranch_scc0 FH37
    v_mov_b64 v[204:205], v[16:17]
    v_mov_b64 v[206:207], v[18:19]
    s_setpc_b64 s[58:59]
FH37:
    v_mov_b64 v[152:153], v[16:17]
    v_mov_b64 v[154:155], v[18:19]
    s_setpc_b64 s[58:59]
OVF3:
    s_sub_u32 s84, s12, 0x1000000
    s_subb_u32 s85, s13, 0
    s_mov_b32 s86, 0x8a0000
    s_mov_b32 s87, 0x20000
    v_bfe_u32 v216, v1, 3, 2
    v_lshlrev_b32 v216, 3, v216
    s_lshl_b32 s62, s3, 6
    s_add_u32 s62, s62, 163008
    v_add_u32 v216, s62, v216
    ds_read_b64 v[248:249], v216
    ds_read_b64 v[250:251], v216 offset:32
    v_lshrrev_b32 v216, 5, v1
    s_waitcnt lgkmcnt(0)
OVL3:
    v_max_u32 v217, v249, v251
    v_cmp_lt_u32 vcc, v216, v217
    s_cbranch_vccz OVX3
    v_lshl_add_u32 v220, v216, 2, v248
    buffer_load_dword v220, v220, s[80:83], 0 offen sc1
    v_lshl_add_u32 v221, v216, 2, v250
    buffer_load_dword v221, v221, s[80:83], 0 offen sc1
    s_waitcnt vmcnt(0)
    v_add_u32 v220, v220, v2
    v_cmp_lt_u32 vcc, v216, v249
    s_nop 1
    v_cndmask_b32 v220, -1, v220, vcc
    buffer_load_dwordx4 v[16:19], v220, s[84:87], 0 offen sc1
    v_add_u32 v221, v221, v2
    v_cmp_lt_u32 vcc, v216, v251
    s_nop 1
    v_cndmask_b32 v221, -1, v221, vcc
    buffer_load_dwordx4 v[20:23], v221, s[84:87], 0 offen sc1
    v_add_u32 v216, 2, v216
    s_waitcnt vmcnt(0)
    v_mfma_f32_16x16x32_bf16 v[152:155], v[8:11], v[16:19], v[152:155]
    v_mfma_f32_16x16x32_bf16 v[156:159], v[8:11], v[20:23], v[156:159]
    s_nop 3
    s_branch OVL3
OVX3:
    ds_read_b32 v220, v4 offset:1800
    s_branch FINB3
HELPER:
    s_setprio 3
    s_mov_b32 s38, s66
    s_mov_b32 s39, 2
    v_lshlrev_b32 v252, 2, v1
    v_add_u32 v252, 161984, v252
    v_subrev_u32 v224, 7168, v224
    v_subrev_u32 v4, 896, v4
    v_mov_b32 v37, 1
    v_mov_b32 v41, 0
    v_mov_b32 v42, 0
H_LOOP:
    ds_read_b32 v36, v252
    s_waitcnt lgkmcnt(0)
    v_and_b32 v36, 7, v36
    v_cmp_eq_u32 vcc, s43, v36
    s_andn2_b32 s41, vcc_lo, s36
    s_and_b32 s41, s41, 0x1ffffff
    s_cbranch_scc0 H_POLL
    s_or_b32 s36, s36, s41
    s_andn2_b32 s41, s41, 0x1fc000
    s_cbranch_scc0 H_CHK
H_ST:
    s_ff1_i32_b32 s62, s41
    s_bitset0_b32 s41, s62
    s_lshl_b32 s63, s62, 10
    s_lshl_b32 s62, s62, 7
    v_add_u32 v24, s63, v224
    v_add_u32 v25, s62, v4
    ds_read_b128 v[28:31], v24
    ds_read_b64 v[32:33], v25
    s_waitcnt lgkmcnt(0)
    v_add_u32 v32, v32, v2
    v_add_u32 v33, v33, v2
    buffer_store_dwordx4 v[28:31], v32, s[12:15], 0 offen sc1
    buffer_store_dwordx4 v[28:31], v33, s[12:15], 0 offen sc1
    s_cmp_lg_u32 s41, 0
    s_cbranch_scc1 H_ST
H_CHK:
    s_cmp_lg_u32 s37, 0
    s_cbranch_scc1 H_L
    s_and_b32 s62, s36, 0x1e0007f
    s_cmp_eq_u32 s62, 0x1e0007f
    s_cbranch_scc0 H_LOOP
    s_mov_b64 exec, 255
    s_waitcnt vmcnt(0)
    buffer_atomic_add v37, v40, s[16:19], 0 offen sc1
    s_mov_b64 exec, -1
    s_add_u32 s37, s37, 1
    s_add_u32 s39, s39, 1
H_L:
    s_cmp_gt_u32 s37, 1
    s_cbranch_scc1 H_L1
    s_bcnt1_i32_b32 s62, s36
    s_cmp_ge_u32 s62, 23
    s_cbranch_scc0 H_LOOP
    buffer_load_dword v38, v7, s[16:19], 0 offen sc1
    s_add_u32 s37, s37, 1
    s_add_u32 s64, s43, 1
    s_mul_i32 s63, s64, 16
    s_lshl_b32 s62, s43, 1
    v_mov_b32 v24, 161696
    v_mov_b32 v25, s64
    s_waitcnt vmcnt(0)
    v_cmp_le_u32 vcc, s63, v38
    s_cmp_eq_u64 vcc, -1
    s_cbranch_scc0 H_L1
    s_cmp_eq_u32 s62, s38
    s_cbranch_scc0 H_L1
    ds_write_b32 v24, v25
    s_add_u32 s38, s38, 1
H_L1:
    s_cmp_eq_u32 s36, 0x1ffffff
    s_cbranch_scc0 H_LOOP
    s_cmp_eq_u32 s42, 0
    s_cbranch_scc1 H_L2
    v_mov_b32 v26, 161696
    v_mov_b32 v27, s42
H_L2:
    s_bitcmp1_b32 s38, 0
    s_cbranch_scc1 H_L2B
    buffer_load_dword v38, v7, s[16:19], 0 offen sc1
H_L2B:
    s_mov_b64 exec, 255
    s_mov_b32 s62, 0x20000
    s_waitcnt vmcnt(0)
    buffer_atomic_add v37, v40, s[16:19], s62 offen sc1
    s_mov_b64 exec, -1
    s_add_u32 s64, s43, 1
    s_mul_i32 s63, s64, 16
    v_cmp_le_u32 vcc, s63, v38
    s_cmp_eq_u64 vcc, -1
    s_cbranch_scc0 H_L3
    s_lshl_b32 s62, s43, 1
    s_cmp_eq_u32 s62, s38
    s_cbranch_scc0 H_L3
    v_mov_b32 v24, 161696
    v_mov_b32 v25, s64
    ds_write_b32 v24, v25
    s_add_u32 s38, s38, 1
    s_cmp_eq_u32 s42, 0
    s_cbranch_scc1 H_L3
    s_mov_b32 s42, 0
H_L3:
    s_add_u32 s39, s39, 1
    s_add_u32 s43, s43, 1
    s_mov_b32 s36, 0
    s_mov_b32 s37, 0
    s_add_u32 s12, s12, 0x1000000
    s_addc_u32 s13, s13, 0
H_POLL:
    s_or_b32 s62, s38, 1
    s_cmp_lt_u32 s62, s39
    s_cbranch_scc0 H_IDLE
    s_bitcmp1_b32 s38, 0
    s_cbranch_scc0 H_P1
    v_mov_b32 v24, 161712
    ds_read_b32 v24, v24
    s_lshr_b32 s64, s38, 1
    s_waitcnt lgkmcnt(0)
    v_readfirstlane_b32 s62, v24
    s_cmp_gt_u32 s62, s64
    s_cbranch_scc0 H_IDLE
H_P1:
    s_and_b32 s62, s38, 1
    s_lshl_b32 s63, s62, 17
    buffer_load_dword v36, v7, s[16:19], s63 offen sc1
    s_lshr_b32 s64, s38, 1
    s_add_u32 s64, s64, 1
    s_mul_i32 s63, s64, 16
    s_lshl_b32 s62, s62, 2
    s_add_u32 s62, s62, 161696
    v_mov_b32 v24, s62
    v_mov_b32 v25, s64
    s_waitcnt vmcnt(0)
    v_cmp_le_u32 vcc, s63, v36
    s_cmp_eq_u64 vcc, -1
    s_cbranch_scc0 H_FAIL
    s_or_b32 s62, s38, 0
    s_add_u32 s38, s38, 1
    s_cmp_lt_u32 s62, s39
    s_cselect_b32 s42, 0, s64
    s_cbranch_scc0 H_LOOP
    ds_write_b32 v24, v25
    s_cmp_eq_u32 s38, 14
    s_cbranch_scc1 H_LAST
    s_cmp_eq_u32 s38, 2
    s_cbranch_scc1 H_VOTE
    s_cmp_eq_u32 s38, 6
    s_cbranch_scc0 H_LOOP
    v_lshlrev_b32 v16, 4, v1
    s_movk_i32 s62, 0
    buffer_load_dwordx4 v[64:67], v16, s[24:27], s62 offen offset:0 sc1
    buffer_load_dwordx4 v[68:71], v16, s[24:27], s62 offen offset:1024 sc1
    buffer_load_dwordx4 v[72:75], v16, s[24:27], s62 offen offset:2048 sc1
    buffer_load_dwordx4 v[76:79], v16, s[24:27], s62 offen offset:3072 sc1
    s_movk_i32 s62, 4096
    buffer_load_dwordx4 v[80:83], v16, s[24:27], s62 offen offset:0 sc1
    buffer_load_dwordx4 v[84:87], v16, s[24:27], s62 offen offset:1024 sc1
    buffer_load_dwordx4 v[88:91], v16, s[24:27], s62 offen offset:2048 sc1
    buffer_load_dwordx4 v[92:95], v16, s[24:27], s62 offen offset:3072 sc1
    s_movk_i32 s62, 8192
    buffer_load_dwordx4 v[96:99], v16, s[24:27], s62 offen offset:0 sc1
    buffer_load_dwordx4 v[100:103], v16, s[24:27], s62 offen offset:1024 sc1
    buffer_load_dwordx4 v[104:107], v16, s[24:27], s62 offen offset:2048 sc1
    buffer_load_dwordx4 v[108:111], v16, s[24:27], s62 offen offset:3072 sc1
    s_movk_i32 s62, 12288
    buffer_load_dwordx4 v[112:115], v16, s[24:27], s62 offen offset:0 sc1
    buffer_load_dwordx4 v[116:119], v16, s[24:27], s62 offen offset:1024 sc1
    buffer_load_dwordx4 v[120:123], v16, s[24:27], s62 offen offset:2048 sc1
    buffer_load_dwordx4 v[124:127], v16, s[24:27], s62 offen offset:3072 sc1
    s_call_b64 s[96:97], ATT_SETUP
    s_branch H_LOOP
H_VOTE:
    s_mov_b32 s62, 524288
    s_mov_b32 s18, 525312
    v_lshlrev_b32 v24, 4, v1
    buffer_load_dwordx4 v[28:31], v24, s[16:19], s62 offen sc1
    s_mov_b32 s18, 0x60000
    s_mov_b32 s64, 0
    s_waitcnt vmcnt(0)
    v_cmp_eq_u32 vcc, 2, v28
    s_bcnt1_i32_b64 s62, vcc
    s_add_u32 s64, s64, s62
    v_cmp_eq_u32 vcc, 1, v28
    s_bcnt1_i32_b64 s62, vcc
    s_sub_u32 s64, s64, s62
    v_cmp_eq_u32 vcc, 2, v29
    s_bcnt1_i32_b64 s62, vcc
    s_add_u32 s64, s64, s62
    v_cmp_eq_u32 vcc, 1, v29
    s_bcnt1_i32_b64 s62, vcc
    s_sub_u32 s64, s64, s62
    v_cmp_eq_u32 vcc, 2, v30
    s_bcnt1_i32_b64 s62, vcc
    s_add_u32 s64, s64, s62
    v_cmp_eq_u32 vcc, 1, v30
    s_bcnt1_i32_b64 s62, vcc
    s_sub_u32 s64, s64, s62
    v_cmp_eq_u32 vcc, 2, v31
    s_bcnt1_i32_b64 s62, vcc
    s_add_u32 s64, s64, s62
    v_cmp_eq_u32 vcc, 1, v31
    s_bcnt1_i32_b64 s62, vcc
    s_sub_u32 s64, s64, s62
    s_cmp_gt_i32 s64, 0
    s_cselect_b32 s64, 1, 0
    v_lshrrev_b32 v24, 2, v1
    v_xor_b32 v24, s64, v24
    v_and_b32 v24, 1, v24
    v_lshl_add_u32 v24, v1, 1, v24
    v_lshlrev_b32 v24, 13, v24
    s_lshr_b32 s62, s2, 4
    s_lshl_b32 s62, s62, 7
    v_add_u32 v40, s62, v24
    s_getreg_b32 s62, hwreg(HW_REG_XCC_ID)
    s_and_b32 s62, s62, 7
    v_readlane_b32 s62, v24, s62
    v_and_b32 v7, 15, v1
    v_lshlrev_b32 v7, 7, v7
    v_add_u32 v7, s62, v7
    v_and_b32 v41, 0x2000, v24
    v_cmp_eq_u32 vcc, 0, v41
    v_mov_b32 v41, 8064
    s_nop 0
    v_cndmask_b32 v41, 0, v41, vcc
    v_add_u32 v41, v41, v24
    s_getreg_b32 s62, hwreg(HW_REG_XCC_ID)
    s_and_b32 s62, s62, 7
    v_readlane_b32 s62, v41, s62
    s_nop 1
    v_mov_b32 v42, s62
    s_branch H_LOOP
H_FAIL:
    s_sleep 4
H_IDLE:
    s_add_u32 s57, s57, 1
    s_cmp_gt_u32 s57, 16777216
    s_cbranch_scc0 H_LOOP
    s_endpgm
H_LAST:
    s_cmp_lg_u32 s2, 0
    s_cbranch_scc1 H_LAST1
    s_load_dwordx2 s[84:85], s[0:1], 80
    s_mov_b32 s86, 256
    s_mov_b32 s87, 0x20000
    v_lshlrev_b32 v24, 6, v1
    v_mov_b32 v25, 0
    s_waitcnt lgkmcnt(0)
    s_mov_b64 exec, 3
    buffer_store_dword v25, v24, s[84:87], 0 offen sc1
    s_mov_b64 exec, -1
H_LAST1:
    s_branch ATT_HELPER
K_PL00:
    s_mov_b64 s[96:97], exec
    v_cmp_ge_i32 vcc, v112, v67
    s_mov_b64 exec, vcc
    v_lshrrev_b32 v54, 22, v96
    v_and_b32 v54, 0x3fc, v54
    ds_read_b32 v54, v54 offset:55296
    v_sub_u32 v52, v112, v67
    s_waitcnt lgkmcnt(0)
    v_lshl_add_u32 v54, v52, 2, v54
    buffer_store_dword v55, v54, s[80:83], 0 offen
    s_andn2_b64 exec, s[96:97], exec
    s_cmp_lg_u32 s70, 0
    s_branch K_PL00R
K_PL01:
    s_mov_b64 s[96:97], exec
    v_cmp_ge_i32 vcc, v113, v71
    s_mov_b64 exec, vcc
    v_lshrrev_b32 v54, 22, v97
    v_and_b32 v54, 0x3fc, v54
    ds_read_b32 v54, v54 offset:55296
    v_sub_u32 v52, v113, v71
    s_waitcnt lgkmcnt(0)
    v_lshl_add_u32 v54, v52, 2, v54
    buffer_store_dword v55, v54, s[80:83], 0 offen
    s_andn2_b64 exec, s[96:97], exec
    s_cmp_lg_u32 s70, 0
    s_branch K_PL01R
K_PL02:
    s_mov_b64 s[96:97], exec
    v_cmp_ge_i32 vcc, v114, v75
    s_mov_b64 exec, vcc
    v_lshrrev_b32 v54, 22, v98
    v_and_b32 v54, 0x3fc, v54
    ds_read_b32 v54, v54 offset:55296
    v_sub_u32 v52, v114, v75
    s_waitcnt lgkmcnt(0)
    v_lshl_add_u32 v54, v52, 2, v54
    buffer_store_dword v55, v54, s[80:83], 0 offen
    s_andn2_b64 exec, s[96:97], exec
    s_cmp_lg_u32 s70, 0
    s_branch K_PL02R
K_PL03:
    s_mov_b64 s[96:97], exec
    v_cmp_ge_i32 vcc, v115, v79
    s_mov_b64 exec, vcc
    v_lshrrev_b32 v54, 22, v99
    v_and_b32 v54, 0x3fc, v54
    ds_read_b32 v54, v54 offset:55296
    v_sub_u32 v52, v115, v79
    s_waitcnt lgkmcnt(0)
    v_lshl_add_u32 v54, v52, 2, v54
    buffer_store_dword v55, v54, s[80:83], 0 offen
    s_andn2_b64 exec, s[96:97], exec
    s_cmp_lg_u32 s70, 0
    s_branch K_PL03R
K_PL10:
    s_mov_b64 s[96:97], exec
    v_cmp_ge_i32 vcc, v116, v67
    s_mov_b64 exec, vcc
    v_lshrrev_b32 v54, 22, v100
    v_and_b32 v54, 0x3fc, v54
    ds_read_b32 v54, v54 offset:55296
    v_sub_u32 v52, v116, v67
    s_waitcnt lgkmcnt(0)
    v_lshl_add_u32 v54, v52, 2, v54
    buffer_store_dword v55, v54, s[80:83], 0 offen
    s_andn2_b64 exec, s[96:97], exec
    s_cmp_lg_u32 s70, 0
    s_branch K_PL10R
K_PL11:
    s_mov_b64 s[96:97], exec
    v_cmp_ge_i32 vcc, v117, v71
    s_mov_b64 exec, vcc
    v_lshrrev_b32 v54, 22, v101
    v_and_b32 v54, 0x3fc, v54
    ds_read_b32 v54, v54 offset:55296
    v_sub_u32 v52, v117, v71
    s_waitcnt lgkmcnt(0)
    v_lshl_add_u32 v54, v52, 2, v54
    buffer_store_dword v55, v54, s[80:83], 0 offen
    s_andn2_b64 exec, s[96:97], exec
    s_cmp_lg_u32 s70, 0
    s_branch K_PL11R
K_PL12:
    s_mov_b64 s[96:97], exec
    v_cmp_ge_i32 vcc, v118, v75
    s_mov_b64 exec, vcc
    v_lshrrev_b32 v54, 22, v102
    v_and_b32 v54, 0x3fc, v54
    ds_read_b32 v54, v54 offset:55296
    v_sub_u32 v52, v118, v75
    s_waitcnt lgkmcnt(0)
    v_lshl_add_u32 v54, v52, 2, v54
    buffer_store_dword v55, v54, s[80:83], 0 offen
    s_andn2_b64 exec, s[96:97], exec
    s_cmp_lg_u32 s70, 0
    s_branch K_PL12R
K_PL13:
    s_mov_b64 s[96:97], exec
    v_cmp_ge_i32 vcc, v119, v79
    s_mov_b64 exec, vcc
    v_lshrrev_b32 v54, 22, v103
    v_and_b32 v54, 0x3fc, v54
    ds_read_b32 v54, v54 offset:55296
    v_sub_u32 v52, v119, v79
    s_waitcnt lgkmcnt(0)
    v_lshl_add_u32 v54, v52, 2, v54
    buffer_store_dword v55, v54, s[80:83], 0 offen
    s_andn2_b64 exec, s[96:97], exec
    s_cmp_lg_u32 s70, 0
    s_branch K_PL13R
K_PL20:
    s_mov_b64 s[96:97], exec
    v_cmp_ge_i32 vcc, v120, v67
    s_mov_b64 exec, vcc
    v_lshrrev_b32 v54, 22, v104
    v_and_b32 v54, 0x3fc, v54
    ds_read_b32 v54, v54 offset:55296
    v_sub_u32 v52, v120, v67
    s_waitcnt lgkmcnt(0)
    v_lshl_add_u32 v54, v52, 2, v54
    buffer_store_dword v55, v54, s[80:83], 0 offen
    s_andn2_b64 exec, s[96:97], exec
    s_cmp_lg_u32 s70, 0
    s_branch K_PL20R
K_PL21:
    s_mov_b64 s[96:97], exec
    v_cmp_ge_i32 vcc, v121, v71
    s_mov_b64 exec, vcc
    v_lshrrev_b32 v54, 22, v105
    v_and_b32 v54, 0x3fc, v54
    ds_read_b32 v54, v54 offset:55296
    v_sub_u32 v52, v121, v71
    s_waitcnt lgkmcnt(0)
    v_lshl_add_u32 v54, v52, 2, v54
    buffer_store_dword v55, v54, s[80:83], 0 offen
    s_andn2_b64 exec, s[96:97], exec
    s_cmp_lg_u32 s70, 0
    s_branch K_PL21R
K_PL22:
    s_mov_b64 s[96:97], exec
    v_cmp_ge_i32 vcc, v122, v75
    s_mov_b64 exec, vcc
    v_lshrrev_b32 v54, 22, v106
    v_and_b32 v54, 0x3fc, v54
    ds_read_b32 v54, v54 offset:55296
    v_sub_u32 v52, v122, v75
    s_waitcnt lgkmcnt(0)
    v_lshl_add_u32 v54, v52, 2, v54
    buffer_store_dword v55, v54, s[80:83], 0 offen
    s_andn2_b64 exec, s[96:97], exec
    s_cmp_lg_u32 s70, 0
    s_branch K_PL22R
K_PL23:
    s_mov_b64 s[96:97], exec
    v_cmp_ge_i32 vcc, v123, v79
    s_mov_b64 exec, vcc
    v_lshrrev_b32 v54, 22, v107
    v_and_b32 v54, 0x3fc, v54
    ds_read_b32 v54, v54 offset:55296
    v_sub_u32 v52, v123, v79
    s_waitcnt lgkmcnt(0)
    v_lshl_add_u32 v54, v52, 2, v54
    buffer_store_dword v55, v54, s[80:83], 0 offen
    s_andn2_b64 exec, s[96:97], exec
    s_cmp_lg_u32 s70, 0
    s_branch K_PL23R
K_PL30:
    s_mov_b64 s[96:97], exec
    v_cmp_ge_i32 vcc, v124, v67
    s_mov_b64 exec, vcc
    v_lshrrev_b32 v54, 22, v108
    v_and_b32 v54, 0x3fc, v54
    ds_read_b32 v54, v54 offset:55296
    v_sub_u32 v52, v124, v67
    s_waitcnt lgkmcnt(0)
    v_lshl_add_u32 v54, v52, 2, v54
    buffer_store_dword v55, v54, s[80:83], 0 offen
    s_andn2_b64 exec, s[96:97], exec
    s_cmp_lg_u32 s70, 0
    s_branch K_PL30R
K_PL31:
    s_mov_b64 s[96:97], exec
    v_cmp_ge_i32 vcc, v125, v71
    s_mov_b64 exec, vcc
    v_lshrrev_b32 v54, 22, v109
    v_and_b32 v54, 0x3fc, v54
    ds_read_b32 v54, v54 offset:55296
    v_sub_u32 v52, v125, v71
    s_waitcnt lgkmcnt(0)
    v_lshl_add_u32 v54, v52, 2, v54
    buffer_store_dword v55, v54, s[80:83], 0 offen
    s_andn2_b64 exec, s[96:97], exec
    s_cmp_lg_u32 s70, 0
    s_branch K_PL31R
K_PL32:
    s_mov_b64 s[96:97], exec
    v_cmp_ge_i32 vcc, v126, v75
    s_mov_b64 exec, vcc
    v_lshrrev_b32 v54, 22, v110
    v_and_b32 v54, 0x3fc, v54
    ds_read_b32 v54, v54 offset:55296
    v_sub_u32 v52, v126, v75
    s_waitcnt lgkmcnt(0)
    v_lshl_add_u32 v54, v52, 2, v54
    buffer_store_dword v55, v54, s[80:83], 0 offen
    s_andn2_b64 exec, s[96:97], exec
    s_cmp_lg_u32 s70, 0
    s_branch K_PL32R
K_PL33:
    s_mov_b64 s[96:97], exec
    v_cmp_ge_i32 vcc, v127, v79
    s_mov_b64 exec, vcc
    v_lshrrev_b32 v54, 22, v111
    v_and_b32 v54, 0x3fc, v54
    ds_read_b32 v54, v54 offset:55296
    v_sub_u32 v52, v127, v79
    s_waitcnt lgkmcnt(0)
    v_lshl_add_u32 v54, v52, 2, v54
    buffer_store_dword v55, v54, s[80:83], 0 offen
    s_andn2_b64 exec, s[96:97], exec
    s_cmp_lg_u32 s70, 0
    s_branch K_PL33R
K_PLT:
    s_mov_b64 s[96:97], exec
    v_cmp_ge_i32 vcc, v59, v67
    s_mov_b64 exec, vcc
    v_lshrrev_b32 v60, 22, v56
    v_and_b32 v60, 0x3fc, v60
    ds_read_b32 v60, v60 offset:55296
    v_sub_u32 v52, v59, v67
    s_waitcnt lgkmcnt(0)
    v_lshl_add_u32 v60, v52, 2, v60
    buffer_store_dword v61, v60, s[80:83], 0 offen
    s_andn2_b64 exec, s[96:97], exec
    s_cmp_lg_u32 s70, 0
    s_branch K_PLTR
K_WEIGHTS:
    v_and_b32 v24, 15, v1
    v_lshrrev_b32 v25, 4, v1
    s_lshr_b32 s62, s3, 1
    s_and_b32 s63, s3, 1
    s_lshl_b32 s64, s62, 4
    v_lshl_add_u32 v28, v25, 2, s64
    v_mul_u32_u24 v28, 65, v28
    s_lshl_b32 s64, s63, 5
    v_add3_u32 v28, v28, v24, s64
    v_lshlrev_b32 v28, 2, v28
    v_add_u32 v28, 112640, v28
    s_add_u32 s48, s6, 0x7182000
    s_addc_u32 s49, s7, 0
    s_mov_b32 s50, 0x4800
    s_mov_b32 s51, 0x20000
    s_add_u32 s64, s76, 81920
    v_lshlrev_b32 v29, 4, v1
    v_add_u32 v29, s64, v29
    ds_write_b128 v29, v[192:195]
    v_lshrrev_b32 v29, 2, v24
    v_lshl_add_u32 v29, v25, 3, v29
    v_lshlrev_b32 v29, 7, v29
    v_and_b32 v30, 3, v24
    v_lshl_add_u32 v29, v30, 3, v29
    s_lshl_b32 s64, s63, 6
    s_add_u32 s64, s64, 81920
    v_add_u32 v29, s64, v29
    s_waitcnt lgkmcnt(0)
    s_barrier
    ds_read_b64_tr_b16 v[232:233], v29 offset:0
    ds_read_b64_tr_b16 v[234:235], v29 offset:512
    ds_read_b64_tr_b16 v[236:237], v29 offset:4096
    ds_read_b64_tr_b16 v[238:239], v29 offset:4608
    ds_read_b64_tr_b16 v[240:241], v29 offset:32
    ds_read_b64_tr_b16 v[242:243], v29 offset:544
    ds_read_b64_tr_b16 v[244:245], v29 offset:4128
    ds_read_b64_tr_b16 v[246:247], v29 offset:4640
    s_waitcnt lgkmcnt(0)
    v_mfma_f32_16x16x32_bf16 v[248:251], v[160:163], v[176:179], 0
    v_mfma_f32_16x16x32_bf16 v[248:251], v[164:167], v[180:183], v[248:251]
    v_mfma_f32_16x16x32_bf16 v[252:255], v[160:163], v[184:187], 0
    v_mfma_f32_16x16x32_bf16 v[252:255], v[164:167], v[188:191], v[252:255]
    v_mfma_f32_16x16x32_bf16 v[184:187], v[168:171], v[232:235], 0
    v_mfma_f32_16x16x32_bf16 v[184:187], v[172:175], v[236:239], v[184:187]
    v_mfma_f32_16x16x32_bf16 v[188:191], v[168:171], v[240:243], 0
    v_mfma_f32_16x16x32_bf16 v[188:191], v[172:175], v[244:247], v[188:191]
    s_nop 7
    v_mov_b32 v232, v184
    v_mov_b32 v184, v248
    v_mov_b32 v233, v185
    v_mov_b32 v185, v249
    v_mov_b32 v234, v186
    v_mov_b32 v186, v250
    v_mov_b32 v235, v187
    v_mov_b32 v187, v251
    v_mov_b32 v236, v188
    v_mov_b32 v188, v252
    v_mov_b32 v237, v189
    v_mov_b32 v189, v253
    v_mov_b32 v238, v190
    v_mov_b32 v190, v254
    v_mov_b32 v239, v191
    v_mov_b32 v191, v255
    ds_write_b32 v28, v184 offset:0
    ds_write_b32 v28, v185 offset:260
    ds_write_b32 v28, v186 offset:520
    ds_write_b32 v28, v187 offset:780
    ds_write_b32 v28, v188 offset:64
    ds_write_b32 v28, v189 offset:324
    ds_write_b32 v28, v190 offset:584
    ds_write_b32 v28, v191 offset:844
    s_lshl_b32 s64, s63, 11
    s_lshl_b32 s65, s62, 4
    s_add_u32 s64, s64, s65
    s_add_u32 s64, s64, 76800
    v_lshlrev_b32 v30, 6, v24
    v_lshl_add_u32 v30, v25, 2, v30
    v_add_u32 v30, s64, v30
    v_add_f32 v31, v184, v185
    v_add_f32 v32, v186, v187
    v_add_f32 v31, v31, v32
    ds_write_b32 v30, v31 offset:0
    v_add_f32 v31, v188, v189
    v_add_f32 v32, v190, v191
    v_add_f32 v31, v31, v32
    ds_write_b32 v30, v31 offset:1024
    v_add_f32 v184, v184, v188
    v_add_f32 v185, v185, v189
    v_add_f32 v186, v186, v190
    v_add_f32 v187, v187, v191
    v_add_f32_dpp v184, v184, v184 row_ror:1 row_mask:0xf bank_mask:0xf
    v_add_f32_dpp v185, v185, v185 row_ror:1 row_mask:0xf bank_mask:0xf
    v_add_f32_dpp v186, v186, v186 row_ror:1 row_mask:0xf bank_mask:0xf
    v_add_f32_dpp v187, v187, v187 row_ror:1 row_mask:0xf bank_mask:0xf
    v_add_f32_dpp v184, v184, v184 row_ror:2 row_mask:0xf bank_mask:0xf
    v_add_f32_dpp v185, v185, v185 row_ror:2 row_mask:0xf bank_mask:0xf
    v_add_f32_dpp v186, v186, v186 row_ror:2 row_mask:0xf bank_mask:0xf
    v_add_f32_dpp v187, v187, v187 row_ror:2 row_mask:0xf bank_mask:0xf
    v_add_f32_dpp v184, v184, v184 row_ror:4 row_mask:0xf bank_mask:0xf
    v_add_f32_dpp v185, v185, v185 row_ror:4 row_mask:0xf bank_mask:0xf
    v_add_f32_dpp v186, v186, v186 row_ror:4 row_mask:0xf bank_mask:0xf
    v_add_f32_dpp v187, v187, v187 row_ror:4 row_mask:0xf bank_mask:0xf
    v_add_f32_dpp v184, v184, v184 row_ror:8 row_mask:0xf bank_mask:0xf
    v_add_f32_dpp v185, v185, v185 row_ror:8 row_mask:0xf bank_mask:0xf
    v_add_f32_dpp v186, v186, v186 row_ror:8 row_mask:0xf bank_mask:0xf
    v_add_f32_dpp v187, v187, v187 row_ror:8 row_mask:0xf bank_mask:0xf
    s_lshl_b32 s64, s62, 7
    s_lshl_b32 s65, s63, 2
    s_add_u32 s64, s64, s65
    s_add_u32 s64, s64, 80896
    v_lshlrev_b32 v30, 5, v25
    v_add_u32 v30, s64, v30
    ds_write_b32 v30, v184 offset:0
    ds_write_b32 v30, v185 offset:8
    ds_write_b32 v30, v186 offset:16
    ds_write_b32 v30, v187 offset:24
    s_waitcnt lgkmcnt(0)
    s_barrier
    v_lshrrev_b32 v30, 2, v24
    v_lshlrev_b32 v30, 3, v30
    v_and_b32 v31, 3, v24
    s_lshr_b32 s64, s62, 1
    s_lshl_b32 s64, s64, 5
    s_and_b32 s65, s62, 1
    s_lshl_b32 s65, s65, 2
    s_add_u32 s64, s64, s65
    v_add3_u32 v30, v30, v31, s64
    s_lshl_b32 s64, s63, 5
    v_lshl_add_u32 v31, v25, 3, s64
    v_mul_u32_u24 v32, 65, v31
    v_add_lshl_u32 v32, v32, v30, 2
    v_add_u32 v32, 112640, v32
    v_lshlrev_b32 v30, 6, v30
    v_add_u32 v30, 76800, v30
    v_lshlrev_b32 v31, 3, v31
    v_add_u32 v31, 80896, v31
    v_lshlrev_b32 v33, 3, v1
    v_add_u32 v33, 80896, v33
    ds_read_b128 v[192:195], v30 offset:0
    ds_read_b128 v[196:199], v30 offset:16
    ds_read_b128 v[200:203], v30 offset:32
    ds_read_b128 v[204:207], v30 offset:48
    ds_read_b128 v[208:211], v31 offset:0
    ds_read_b128 v[212:215], v31 offset:16
    ds_read_b128 v[216:219], v31 offset:32
    ds_read_b128 v[220:223], v31 offset:48
    ds_read_b64 v[34:35], v33
    ds_read_b32 v160, v32 offset:0
    ds_read_b32 v161, v32 offset:260
    ds_read_b32 v162, v32 offset:520
    ds_read_b32 v163, v32 offset:780
    ds_read_b32 v164, v32 offset:1040
    ds_read_b32 v165, v32 offset:1300
    ds_read_b32 v166, v32 offset:1560
    ds_read_b32 v167, v32 offset:1820
    s_mov_b32 s64, 0x4438aa3b
    s_mov_b32 s65, 0xbc800000
    s_waitcnt lgkmcnt(0)
    v_add_f32 v192, v192, v193
    v_add_f32 v192, v192, v194
    v_add_f32 v192, v192, v195
    v_add_f32 v192, v192, v196
    v_add_f32 v192, v192, v197
    v_add_f32 v192, v192, v198
    v_add_f32 v192, v192, v199
    v_add_f32 v192, v192, v200
    v_add_f32 v192, v192, v201
    v_add_f32 v192, v192, v202
    v_add_f32 v192, v192, v203
    v_add_f32 v192, v192, v204
    v_add_f32 v192, v192, v205
    v_add_f32 v192, v192, v206
    v_add_f32 v192, v192, v207
    v_add_f32 v34, v34, v35
    s_nop 1
    v_add_f32_dpp v34, v34, v34 row_shr:1 row_mask:0xf bank_mask:0xf
    s_nop 1
    v_add_f32_dpp v34, v34, v34 row_shr:2 row_mask:0xf bank_mask:0xf
    s_nop 1
    v_add_f32_dpp v34, v34, v34 row_shr:4 row_mask:0xf bank_mask:0xf
    s_nop 1
    v_add_f32_dpp v34, v34, v34 row_shr:8 row_mask:0xf bank_mask:0xf
    s_nop 1
    v_add_f32_dpp v34, v34, v34 row_bcast:15 row_mask:0xa bank_mask:0xf
    s_nop 1
    v_add_f32_dpp v34, v34, v34 row_bcast:31 row_mask:0xc bank_mask:0xf
    s_nop 0
    v_readlane_b32 s66, v34, 63
    s_nop 1
    v_mov_b32 v34, s66
    v_fma_f32 v192, v34, s65, v192
    v_fma_f32 v160, v192, s65, v160
    v_add_f32 v208, v208, v209
    v_fma_f32 v160, v208, s65, v160
    v_mul_f32 v160, s64, v160
    v_fma_f32 v161, v192, s65, v161
    v_add_f32 v210, v210, v211
    v_fma_f32 v161, v210, s65, v161
    v_mul_f32 v161, s64, v161
    v_fma_f32 v162, v192, s65, v162
    v_add_f32 v212, v212, v213
    v_fma_f32 v162, v212, s65, v162
    v_mul_f32 v162, s64, v162
    v_fma_f32 v163, v192, s65, v163
    v_add_f32 v214, v214, v215
    v_fma_f32 v163, v214, s65, v163
    v_mul_f32 v163, s64, v163
    v_fma_f32 v164, v192, s65, v164
    v_add_f32 v216, v216, v217
    v_fma_f32 v164, v216, s65, v164
    v_mul_f32 v164, s64, v164
    v_fma_f32 v165, v192, s65, v165
    v_add_f32 v218, v218, v219
    v_fma_f32 v165, v218, s65, v165
    v_mul_f32 v165, s64, v165
    v_fma_f32 v166, v192, s65, v166
    v_add_f32 v220, v220, v221
    v_fma_f32 v166, v220, s65, v166
    v_mul_f32 v166, s64, v166
    v_fma_f32 v167, v192, s65, v167
    v_add_f32 v222, v222, v223
    v_fma_f32 v167, v222, s65, v167
    v_mul_f32 v167, s64, v167
    v_cvt_pk_bf16_f32 v176, v160, v161
    v_cvt_pk_bf16_f32 v177, v162, v163
    v_cvt_pk_bf16_f32 v178, v164, v165
    v_cvt_pk_bf16_f32 v179, v166, v167
    v_lshlrev_b32 v30, 4, v1
    s_add_u32 s64, s76, 0
    buffer_store_dwordx4 v[176:179], v30, s[48:51], s64 offen sc1
    s_barrier
    v_mov_b32 v184, v232
    v_mov_b32 v185, v233
    v_mov_b32 v186, v234
    v_mov_b32 v187, v235
    v_mov_b32 v188, v236
    v_mov_b32 v189, v237
    v_mov_b32 v190, v238
    v_mov_b32 v191, v239
    ds_write_b32 v28, v184 offset:0
    ds_write_b32 v28, v185 offset:260
    ds_write_b32 v28, v186 offset:520
    ds_write_b32 v28, v187 offset:780
    ds_write_b32 v28, v188 offset:64
    ds_write_b32 v28, v189 offset:324
    ds_write_b32 v28, v190 offset:584
    ds_write_b32 v28, v191 offset:844
    s_lshl_b32 s64, s63, 11
    s_lshl_b32 s65, s62, 4
    s_add_u32 s64, s64, s65
    s_add_u32 s64, s64, 76800
    v_lshlrev_b32 v30, 6, v24
    v_lshl_add_u32 v30, v25, 2, v30
    v_add_u32 v30, s64, v30
    v_add_f32 v31, v184, v185
    v_add_f32 v32, v186, v187
    v_add_f32 v31, v31, v32
    ds_write_b32 v30, v31 offset:0
    v_add_f32 v31, v188, v189
    v_add_f32 v32, v190, v191
    v_add_f32 v31, v31, v32
    ds_write_b32 v30, v31 offset:1024
    s_waitcnt lgkmcnt(0)
    s_barrier
    s_lshl_b32 s64, s62, 4
    v_add_u32 v30, s64, v24
    s_lshl_b32 s64, s63, 5
    v_lshl_add_u32 v31, v25, 3, s64
    v_mul_u32_u24 v32, 65, v31
    v_add_lshl_u32 v32, v32, v30, 2
    v_add_u32 v32, 112640, v32
    v_lshlrev_b32 v30, 6, v30
    v_add_u32 v30, 76800, v30
    v_lshlrev_b32 v31, 3, v31
    v_add_u32 v31, 80896, v31
    v_lshlrev_b32 v33, 3, v1
    v_add_u32 v33, 80896, v33
    ds_read_b128 v[192:195], v30 offset:0
    ds_read_b128 v[196:199], v30 offset:16
    ds_read_b128 v[200:203], v30 offset:32
    ds_read_b128 v[204:207], v30 offset:48
    ds_read_b32 v160, v32 offset:0
    ds_read_b32 v161, v32 offset:260
    ds_read_b32 v162, v32 offset:520
    ds_read_b32 v163, v32 offset:780
    ds_read_b32 v164, v32 offset:1040
    ds_read_b32 v165, v32 offset:1300
    ds_read_b32 v166, v32 offset:1560
    ds_read_b32 v167, v32 offset:1820
    s_mov_b32 s64, 0x42800000
    s_mov_b32 s65, 0xbc800000
    s_waitcnt lgkmcnt(0)
    v_add_f32 v192, v192, v193
    v_add_f32 v192, v192, v194
    v_add_f32 v192, v192, v195
    v_add_f32 v192, v192, v196
    v_add_f32 v192, v192, v197
    v_add_f32 v192, v192, v198
    v_add_f32 v192, v192, v199
    v_add_f32 v192, v192, v200
    v_add_f32 v192, v192, v201
    v_add_f32 v192, v192, v202
    v_add_f32 v192, v192, v203
    v_add_f32 v192, v192, v204
    v_add_f32 v192, v192, v205
    v_add_f32 v192, v192, v206
    v_add_f32 v192, v192, v207
    v_fma_f32 v160, v192, s65, v160
    v_mul_f32 v160, s64, v160
    v_fma_f32 v161, v192, s65, v161
    v_mul_f32 v161, s64, v161
    v_fma_f32 v162, v192, s65, v162
    v_mul_f32 v162, s64, v162
    v_fma_f32 v163, v192, s65, v163
    v_mul_f32 v163, s64, v163
    v_fma_f32 v164, v192, s65, v164
    v_mul_f32 v164, s64, v164
    v_fma_f32 v165, v192, s65, v165
    v_mul_f32 v165, s64, v165
    v_fma_f32 v166, v192, s65, v166
    v_mul_f32 v166, s64, v166
    v_fma_f32 v167, v192, s65, v167
    v_mul_f32 v167, s64, v167
    v_cvt_pk_bf16_f32 v176, v160, v161
    v_cvt_pk_bf16_f32 v177, v162, v163
    v_cvt_pk_bf16_f32 v178, v164, v165
    v_cvt_pk_bf16_f32 v179, v166, v167
    v_lshlrev_b32 v30, 4, v1
    s_add_u32 s64, s76, 8192
    buffer_store_dwordx4 v[176:179], v30, s[48:51], s64 offen sc1
    s_barrier
    s_cmp_ge_u32 s3, 2
    s_cbranch_scc1 K_WDONE
    v_lshlrev_b32 v32, 16, v228
    v_mov_b32 v160, v224
    v_mov_b32 v161, v225
    v_mov_b32 v162, v226
    v_mov_b32 v163, v227
    v_add_f32_dpp v32, v32, v32 row_shr:1 row_mask:0xf bank_mask:0xf
    s_nop 1
    v_add_f32_dpp v32, v32, v32 row_shr:2 row_mask:0xf bank_mask:0xf
    s_nop 1
    v_add_f32_dpp v32, v32, v32 row_shr:4 row_mask:0xf bank_mask:0xf
    s_nop 1
    v_add_f32_dpp v32, v32, v32 row_shr:8 row_mask:0xf bank_mask:0xf
    s_nop 1
    v_add_f32_dpp v32, v32, v32 row_bcast:15 row_mask:0xa bank_mask:0xf
    s_nop 1
    v_add_f32_dpp v32, v32, v32 row_bcast:31 row_mask:0xc bank_mask:0xf
    s_nop 0
    v_readlane_b32 s65, v32, 63
    s_nop 1
    v_mov_b32 v32, s65
    v_mul_f32 v32, 0x3c800000, v32
    s_mov_b32 s64, 0x42b8aa3b
    v_and_b32 v33, 3, v24
    v_mov_b32 v34, 0x3f803f80
    v_lshlrev_b32 v164, 16, v160
    v_and_b32 v165, 0xffff0000, v160
    v_sub_f32 v164, v164, v32
    v_sub_f32 v165, v165, v32
    v_mul_f32 v164, s64, v164
    v_mul_f32 v165, s64, v165
    v_cvt_pk_bf16_f32 v160, v164, v165
    v_cmp_eq_u32 vcc, 1, v33
    s_nop 1
    v_cndmask_b32 v160, 0, v160, vcc
    v_cmp_eq_u32 vcc, 0, v33
    s_nop 1
    v_cndmask_b32 v160, v160, v34, vcc
    v_lshlrev_b32 v164, 16, v161
    v_and_b32 v165, 0xffff0000, v161
    v_sub_f32 v164, v164, v32
    v_sub_f32 v165, v165, v32
    v_mul_f32 v164, s64, v164
    v_mul_f32 v165, s64, v165
    v_cvt_pk_bf16_f32 v161, v164, v165
    v_cmp_eq_u32 vcc, 1, v33
    s_nop 1
    v_cndmask_b32 v161, 0, v161, vcc
    v_cmp_eq_u32 vcc, 0, v33
    s_nop 1
    v_cndmask_b32 v161, v161, v34, vcc
    v_lshlrev_b32 v164, 16, v162
    v_and_b32 v165, 0xffff0000, v162
    v_sub_f32 v164, v164, v32
    v_sub_f32 v165, v165, v32
    v_mul_f32 v164, s64, v164
    v_mul_f32 v165, s64, v165
    v_cvt_pk_bf16_f32 v162, v164, v165
    v_cmp_eq_u32 vcc, 1, v33
    s_nop 1
    v_cndmask_b32 v162, 0, v162, vcc
    v_cmp_eq_u32 vcc, 0, v33
    s_nop 1
    v_cndmask_b32 v162, v162, v34, vcc
    v_lshlrev_b32 v164, 16, v163
    v_and_b32 v165, 0xffff0000, v163
    v_sub_f32 v164, v164, v32
    v_sub_f32 v165, v165, v32
    v_mul_f32 v164, s64, v164
    v_mul_f32 v165, s64, v165
    v_cvt_pk_bf16_f32 v163, v164, v165
    v_cmp_eq_u32 vcc, 1, v33
    s_nop 1
    v_cndmask_b32 v163, 0, v163, vcc
    v_cmp_eq_u32 vcc, 0, v33
    s_nop 1
    v_cndmask_b32 v163, v163, v34, vcc
    s_add_u32 s64, s76, 16384
    buffer_store_dwordx4 v[160:163], v30, s[48:51], s64 offen sc1
K_WDONE:
    s_cmp_eq_u32 s3, 7
    s_cbranch_scc1 K_W1
    s_waitcnt vmcnt(3)
    v_lshlrev_b32 v49, 16, v80
    v_lshlrev_b32 v52, 16, v64
    v_and_b32 v53, 0xffff0000, v64
    v_lshlrev_b32 v54, 16, v65
    v_and_b32 v55, 0xffff0000, v65
    v_lshlrev_b32 v56, 16, v66
    v_and_b32 v57, 0xffff0000, v66
    v_lshlrev_b32 v58, 16, v67
    v_and_b32 v59, 0xffff0000, v67
    v_mul_f32 v52, v49, v52
    v_mul_f32 v53, v49, v53
    v_mul_f32 v54, v49, v54
    v_mul_f32 v55, v49, v55
    v_mul_f32 v56, v49, v56
    v_mul_f32 v57, v49, v57
    v_mul_f32 v58, v49, v58
    v_mul_f32 v59, v49, v59
    v_cvt_pk_bf16_f32 v64, v52, v53
    v_cvt_pk_bf16_f32 v65, v54, v55
    v_cvt_pk_bf16_f32 v66, v56, v57
    v_cvt_pk_bf16_f32 v67, v58, v59
    buffer_store_dwordx4 v[64:67], v112, s[12:15], 0 offen sc1
    buffer_store_dwordx4 v[64:67], v113, s[12:15], 0 offen sc1
    v_lshlrev_b32 v49, 16, v81
    v_lshlrev_b32 v52, 16, v68
    v_and_b32 v53, 0xffff0000, v68
    v_lshlrev_b32 v54, 16, v69
    v_and_b32 v55, 0xffff0000, v69
    v_lshlrev_b32 v56, 16, v70
    v_and_b32 v57, 0xffff0000, v70
    v_lshlrev_b32 v58, 16, v71
    v_and_b32 v59, 0xffff0000, v71
    v_mul_f32 v52, v49, v52
    v_mul_f32 v53, v49, v53
    v_mul_f32 v54, v49, v54
    v_mul_f32 v55, v49, v55
    v_mul_f32 v56, v49, v56
    v_mul_f32 v57, v49, v57
    v_mul_f32 v58, v49, v58
    v_mul_f32 v59, v49, v59
    v_cvt_pk_bf16_f32 v68, v52, v53
    v_cvt_pk_bf16_f32 v69, v54, v55
    v_cvt_pk_bf16_f32 v70, v56, v57
    v_cvt_pk_bf16_f32 v71, v58, v59
    buffer_store_dwordx4 v[68:71], v114, s[12:15], 0 offen sc1
    buffer_store_dwordx4 v[68:71], v115, s[12:15], 0 offen sc1
    v_lshlrev_b32 v49, 16, v82
    v_lshlrev_b32 v52, 16, v72
    v_and_b32 v53, 0xffff0000, v72
    v_lshlrev_b32 v54, 16, v73
    v_and_b32 v55, 0xffff0000, v73
    v_lshlrev_b32 v56, 16, v74
    v_and_b32 v57, 0xffff0000, v74
    v_lshlrev_b32 v58, 16, v75
    v_and_b32 v59, 0xffff0000, v75
    v_mul_f32 v52, v49, v52
    v_mul_f32 v53, v49, v53
    v_mul_f32 v54, v49, v54
    v_mul_f32 v55, v49, v55
    v_mul_f32 v56, v49, v56
    v_mul_f32 v57, v49, v57
    v_mul_f32 v58, v49, v58
    v_mul_f32 v59, v49, v59
    v_cvt_pk_bf16_f32 v72, v52, v53
    v_cvt_pk_bf16_f32 v73, v54, v55
    v_cvt_pk_bf16_f32 v74, v56, v57
    v_cvt_pk_bf16_f32 v75, v58, v59
    buffer_store_dwordx4 v[72:75], v116, s[12:15], 0 offen sc1
    buffer_store_dwordx4 v[72:75], v117, s[12:15], 0 offen sc1
    v_lshlrev_b32 v49, 16, v83
    v_lshlrev_b32 v52, 16, v76
    v_and_b32 v53, 0xffff0000, v76
    v_lshlrev_b32 v54, 16, v77
    v_and_b32 v55, 0xffff0000, v77
    v_lshlrev_b32 v56, 16, v78
    v_and_b32 v57, 0xffff0000, v78
    v_lshlrev_b32 v58, 16, v79
    v_and_b32 v59, 0xffff0000, v79
    v_mul_f32 v52, v49, v52
    v_mul_f32 v53, v49, v53
    v_mul_f32 v54, v49, v54
    v_mul_f32 v55, v49, v55
    v_mul_f32 v56, v49, v56
    v_mul_f32 v57, v49, v57
    v_mul_f32 v58, v49, v58
    v_mul_f32 v59, v49, v59
    v_cvt_pk_bf16_f32 v76, v52, v53
    v_cvt_pk_bf16_f32 v77, v54, v55
    v_cvt_pk_bf16_f32 v78, v56, v57
    v_cvt_pk_bf16_f32 v79, v58, v59
    buffer_store_dwordx4 v[76:79], v118, s[12:15], 0 offen sc1
    buffer_store_dwordx4 v[76:79], v119, s[12:15], 0 offen sc1
K_W1:
    s_waitcnt vmcnt(0)
    s_barrier
    s_cmp_eq_u32 s3, 7
    s_cbranch_scc0 K_WBACK
    v_lshlrev_b32 v29, 13, v1
    s_mov_b32 exec_hi, 0
    s_lshr_b32 s62, s2, 4
    s_lshl_b32 s62, s62, 7
    buffer_atomic_add v50, v29, s[16:19], s62 offen sc1
    s_mov_b64 exec, -1
    s_branch K_GO
ATT_SETUP:
    s_load_dwordx2 s[20:21], s[0:1], 72
    v_lshlrev_b32 v227, 4, v1
    s_movk_i32 s62, 16384
    buffer_load_dwordx4 v[208:211], v227, s[24:27], s62 offen sc1
    buffer_load_dwordx4 v[212:215], v227, s[24:27], s62 offen offset:1024 sc1
    s_mul_i32 s63, s3, 5120
    s_add_u32 s63, s63, 76800
    s_movk_i32 s64, 1024
    s_movk_i32 s6, 7168
    s_cmp_eq_u32 s3, 7
    s_cselect_b32 s7, 21, s3
    s_cselect_b32 s63, 112640, s63
    s_cselect_b32 s64, 4096, s64
    s_cselect_b32 s65, 161536, s71
    s_cselect_b32 s6, 1024, s6
    s_mov_b32 s67, s63
    s_lshl_b32 s62, s7, 10
    s_mul_i32 s66, s64, 3
    s_sub_u32 s63, s63, s66
    s_movk_i32 s66, 25600
    v_add_u32 v247, s67, v6
    v_and_b32 v16, 15, v1
    v_lshrrev_b32 v17, 4, v1
    v_and_b32 v18, 7, v16
    v_mul_lo_u32 v21, v18, s64
    v_add_u32 v21, s63, v21
    v_mul_lo_u32 v19, v18, s66
    v_add_u32 v19, s62, v19
    v_cmp_gt_u32 vcc, 3, v18
    s_nop 1
    v_cndmask_b32 v21, v21, v19, vcc
    s_mov_b64 s[32:33], vcc
    v_lshrrev_b32 v19, 3, v16
    v_xor_b32 v20, v19, v18
    v_and_b32 v20, 1, v20
    v_lshl_add_u32 v229, v20, 7, v21
    v_and_b32 v20, 6, v18
    v_xor_b32 v20, v20, v17
    v_lshl_add_u32 v229, v20, 4, v229
    v_xor_b32 v230, 64, v229
    v_lshl_add_u32 v21, v19, 7, v21
    v_xor_b32 v19, v19, v17
    v_and_b32 v19, 1, v19
    v_lshl_add_u32 v21, v19, 3, v21
    v_lshlrev_b32 v235, 1, v18
    v_and_b32 v235, 6, v235
    v_lshrrev_b32 v20, 2, v18
    v_or_b32 v235, v235, v20
    v_lshlrev_b32 v235, 4, v235
    v_lshrrev_b32 v19, 1, v17
    v_lshlrev_b32 v19, 4, v19
    v_xor_b32 v235, v235, v19
    v_add_u32 v235, v235, v21
    v_xor_b32 v236, 32, v235
    v_xor_b32 v237, 64, v235
    v_xor_b32 v238, 96, v235
    v_and_b32 v19, 1, v17
    v_lshrrev_b32 v18, 2, v16
    v_lshl_add_u32 v18, v19, 2, v18
    v_mul_lo_u32 v21, v18, s64
    v_add_u32 v21, s63, v21
    v_mul_lo_u32 v19, v18, s66
    v_add_u32 v19, s62, v19
    v_cmp_gt_u32 vcc, 3, v18
    s_nop 1
    v_cndmask_b32 v21, v21, v19, vcc
    s_mov_b64 s[34:35], vcc
    v_lshrrev_b32 v19, 1, v17
    v_xor_b32 v19, v19, v18
    v_and_b32 v19, 1, v19
    v_lshl_add_u32 v21, v19, 7, v21
    v_and_b32 v19, 6, v18
    v_lshl_add_u32 v21, v19, 4, v21
    v_and_b32 v19, 3, v16
    v_lshl_add_u32 v231, v19, 3, v21
    v_xor_b32 v232, 32, v231
    v_xor_b32 v233, 64, v231
    v_xor_b32 v234, 96, v231
    v_lshrrev_b32 v18, 2, v16
    v_mul_lo_u32 v21, v18, s64
    v_add_u32 v21, s63, v21
    v_mul_lo_u32 v19, v18, s66
    v_add_u32 v19, s62, v19
    v_cmp_gt_u32 vcc, 3, v18
    s_nop 1
    v_cndmask_b32 v21, v21, v19, vcc
    s_mov_b64 s[60:61], vcc
    v_lshl_add_u32 v21, v17, 7, v21
    v_lshlrev_b32 v239, 1, v18
    v_and_b32 v239, 6, v239
    v_lshrrev_b32 v20, 2, v18
    v_or_b32 v239, v239, v20
    v_lshlrev_b32 v239, 4, v239
    v_and_b32 v19, 3, v16
    v_and_b32 v20, 1, v17
    v_xor_b32 v19, v19, v20
    v_lshlrev_b32 v19, 3, v19
    v_xor_b32 v239, v239, v19
    v_add_u32 v239, v239, v21
    v_lshrrev_b32 v18, 2, v16
    v_add_u32 v18, 4, v18
    v_mul_lo_u32 v21, v18, s64
    v_add_u32 v21, s63, v21
    v_mul_lo_u32 v19, v18, s66
    v_add_u32 v19, s62, v19
    v_cmp_gt_u32 vcc, 3, v18
    s_nop 1
    v_cndmask_b32 v21, v21, v19, vcc
    v_lshl_add_u32 v21, v17, 7, v21
    v_lshlrev_b32 v240, 1, v18
    v_and_b32 v240, 6, v240
    v_lshrrev_b32 v20, 2, v18
    v_or_b32 v240, v240, v20
    v_lshlrev_b32 v240, 4, v240
    v_and_b32 v19, 3, v16
    v_and_b32 v20, 1, v17
    v_xor_b32 v19, v19, v20
    v_lshlrev_b32 v19, 3, v19
    v_xor_b32 v240, v240, v19
    v_add_u32 v240, v240, v21
    s_lshl_b32 s66, s7, 8
    s_add_u32 s66, s66, 133120
    v_lshrrev_b32 v19, 1, v17
    v_lshrrev_b32 v20, 3, v16
    v_xor_b32 v20, v20, v19
    v_cmp_eq_u32 vcc, 0, v20
    s_nop 1
    v_cndmask_b32 v228, 0, -1, vcc
    v_lshl_add_u32 v19, v20, 1, v19
    v_lshlrev_b32 v19, 5, v19
    v_add_u32 v19, s66, v19
    v_and_b32 v20, 7, v16
    v_lshl_add_u32 v241, v20, 2, v19
    s_lshl_b32 s66, s7, 7
    s_add_u32 s66, s66, 139532
    v_lshlrev_b32 v246, 4, v20
    v_add_u32 v246, s66, v246
    v_and_b32 v20, 1, v17
    v_lshl_add_u32 v242, v20, 4, v19
    v_lshlrev_b32 v243, 1, v1
    v_add_u32 v243, s65, v243
    v_lshlrev_b32 v19, 4, v17
    v_add_u32 v19, s65, v19
    v_mov_b32 v20, 161664
    v_and_b32 v21, 7, v16
    v_cmp_eq_u32 vcc, v21, v17
    s_nop 1
    v_cndmask_b32 v244, v20, v19, vcc
    v_add_u32 v19, 64, v19
    v_add_u32 v18, 4, v17
    v_cmp_eq_u32 vcc, v21, v18
    s_nop 1
    v_cndmask_b32 v245, v20, v19, vcc
    v_and_b32 v19, 1, v17
    v_lshlrev_b32 v19, 5, v19
    v_and_b32 v20, 2, v17
    v_lshl_add_u32 v19, v20, 3, v19
    v_and_b32 v20, 8, v16
    v_lshl_add_u32 v253, v20, 3, v19
    s_nop 0
    v_lshlrev_b32 v19, 2, v17
    v_sub_u32 v19, v16, v19
    v_mov_b32 v20, 0x3f80
    v_mov_b32 v18, 1.0
    v_cmp_eq_u32 vcc, 0, v19
    s_nop 1
    v_cndmask_b32 v218, 0, v20, vcc
    v_cmp_eq_u32 vcc, 1, v19
    s_nop 1
    v_cndmask_b32 v218, v218, v18, vcc
    v_mov_b32 v222, v218
    v_cmp_eq_u32 vcc, 2, v19
    s_nop 1
    v_cndmask_b32 v219, 0, v20, vcc
    v_cmp_eq_u32 vcc, 3, v19
    s_nop 1
    v_cndmask_b32 v219, v219, v18, vcc
    v_mov_b32 v223, v219
    s_mov_b32 s88, 0xaaaaaaaa
    s_mov_b32 s89, 0xaaaaaaaa
    s_mov_b32 s90, 0xcccccccc
    s_mov_b32 s91, 0xcccccccc
    s_mov_b32 s92, 0x00f0000f
    s_mov_b32 s93, 0xf0000f00
    s_lshl_b32 s66, s7, 8
    s_add_u32 s66, s66, 133120
    v_lshlrev_b32 v226, 2, v1
    v_add_u32 v226, s66, v226
    s_add_u32 s66, s65, 128
    s_cmp_eq_u32 s3, 7
    s_cselect_b32 s66, 161728, s66
    v_lshlrev_b32 v225, 2, v16
    v_add_u32 v225, s66, v225
    s_lshl_b32 s72, s65, 1
    s_sub_u32 s72, s66, s72
    s_mov_b32 s94, 0xffff0000
    s_mov_b32 s95, 0
    s_mov_b32 s28, 0
    s_mov_b32 s29, 0xffff
    s_mov_b32 s30, 0
    s_mov_b32 s31, 0xffff0000
    s_lshr_b32 s75, s6, 2
    s_lshr_b32 s40, s6, 3
    s_cmp_eq_u32 s3, 7
    s_cselect_b32 s68, 1024, 0
    s_cselect_b64 s[32:33], -1, s[32:33]
    s_cselect_b64 s[34:35], -1, s[34:35]
    s_cselect_b64 s[60:61], -1, s[60:61]
    s_waitcnt lgkmcnt(0)
    s_mov_b32 s22, 6400000
    s_mov_b32 s23, 0x20000
    s_setpc_b64 s[96:97]
ENGINE_DONE:
ATT_ALL:
    s_mov_b32 vcc_lo, 0x00ff00ff
    s_mov_b32 vcc_hi, 0xff00ff00
    s_mov_b32 s78, 0xff00ff00
    s_mov_b32 s79, 0xff00ff00
    v_xor_b32 v227, 160, v247
    s_setprio 2
    ds_write_b128 v227, v[160:163] offset:0
    v_xor_b32 v227, 64, v247
    ds_write_b128 v227, v[164:167] offset:1024
    v_xor_b32 v227, 192, v247
    ds_write_b128 v227, v[168:171] offset:2048
    v_xor_b32 v227, 96, v247
    ds_write_b128 v227, v[172:175] offset:3072
    v_xor_b32 v227, 224, v247
    ds_write_b128 v227, v[136:139] offset:4096
    ds_read_b128 v[8:11], v229 offset:0
    ds_read_b128 v[16:19], v229 offset:256
    ds_read_b128 v[12:15], v230 offset:0
    ds_read_b128 v[20:23], v230 offset:256
    ds_read_b128 v[4:7], v242 offset:0
    ds_read_b32 v252, v241 offset:0
    ds_read_b64_tr_b16 v[150:151], v231 offset:0
    ds_read_b64_tr_b16 v[170:171], v231 offset:256
    ds_read_b64_tr_b16 v[158:159], v232 offset:0
    ds_read_b64_tr_b16 v[174:175], v232 offset:256
    ds_read_b64_tr_b16 v[162:163], v233 offset:0
    ds_read_b64_tr_b16 v[166:167], v234 offset:0
    ds_read_b64_tr_b16 v[138:139], v233 offset:256
    ds_read_b64_tr_b16 v[142:143], v234 offset:256
    v_lshl_add_u32 v227, v243, 1, s72
    s_waitcnt lgkmcnt(13)
    v_mfma_f32_16x16x32_bf16 v[24:27], v[64:67], v[8:11], 0
    v_mfma_f32_16x16x32_bf16 v[28:31], v[72:75], v[8:11], 0
    s_waitcnt lgkmcnt(12)
    v_mfma_f32_16x16x32_bf16 v[40:43], v[64:67], v[16:19], 0
    v_mfma_f32_16x16x32_bf16 v[44:47], v[72:75], v[16:19], 0
    v_mfma_f32_16x16x32_bf16 v[32:35], v[80:83], v[8:11], 0
    v_mfma_f32_16x16x32_bf16 v[36:39], v[88:91], v[8:11], 0
    v_mfma_f32_16x16x32_bf16 v[48:51], v[80:83], v[16:19], 0
    v_mfma_f32_16x16x32_bf16 v[52:55], v[88:91], v[16:19], 0
    s_waitcnt lgkmcnt(11)
    v_mfma_f32_16x16x32_bf16 v[24:27], v[68:71], v[12:15], v[24:27]
    v_mfma_f32_16x16x32_bf16 v[28:31], v[76:79], v[12:15], v[28:31]
    s_waitcnt lgkmcnt(10)
    v_mfma_f32_16x16x32_bf16 v[40:43], v[68:71], v[20:23], v[40:43]
    v_mfma_f32_16x16x32_bf16 v[44:47], v[76:79], v[20:23], v[44:47]
    v_mfma_f32_16x16x32_bf16 v[32:35], v[84:87], v[12:15], v[32:35]
    v_mfma_f32_16x16x32_bf16 v[36:39], v[92:95], v[12:15], v[36:39]
    v_mfma_f32_16x16x32_bf16 v[48:51], v[84:87], v[20:23], v[48:51]
    v_mfma_f32_16x16x32_bf16 v[52:55], v[92:95], v[20:23], v[52:55]
    v_cvt_pk_bf16_f32 v56, v24, v25
    v_cvt_pk_bf16_f32 v57, v26, v27
    v_cvt_pk_bf16_f32 v58, v28, v29
    v_cvt_pk_bf16_f32 v59, v30, v31
    v_cvt_pk_bf16_f32 v128, v40, v41
    v_cvt_pk_bf16_f32 v129, v42, v43
    v_mfma_f32_16x16x32_bf16 v[248:251], v[8:11], v[56:59], 0
    v_cvt_pk_bf16_f32 v130, v44, v45
    v_cvt_pk_bf16_f32 v131, v46, v47
    v_cvt_pk_bf16_f32 v60, v32, v33
    v_cvt_pk_bf16_f32 v61, v34, v35
    v_mfma_f32_16x16x32_bf16 v[0:3], v[16:19], v[128:131], 0
    v_cvt_pk_bf16_f32 v62, v36, v37
    v_cvt_pk_bf16_f32 v63, v38, v39
    v_cvt_pk_bf16_f32 v132, v48, v49
    v_cvt_pk_bf16_f32 v133, v50, v51
    v_mfma_f32_16x16x32_bf16 v[248:251], v[12:15], v[60:63], v[248:251]
    v_cvt_pk_bf16_f32 v134, v52, v53
    v_cvt_pk_bf16_f32 v135, v54, v55
    s_nop 1
    v_mfma_f32_16x16x32_bf16 v[0:3], v[20:23], v[132:135], v[0:3]
    v_mfma_f32_16x16x32_bf16 v[24:27], v[8:11], v[96:99], 0
    v_mfma_f32_16x16x32_bf16 v[24:27], v[12:15], v[100:103], v[24:27]
    v_mfma_f32_16x16x32_bf16 v[28:31], v[8:11], v[104:107], 0
    v_mfma_f32_16x16x32_bf16 v[28:31], v[12:15], v[108:111], v[28:31]
    s_nop 3
    v_cndmask_b32_dpp v56, v0, v248, vcc row_ror:8 row_mask:0xf bank_mask:0xf
    v_mfma_f32_16x16x32_bf16 v[32:35], v[8:11], v[112:115], 0
    s_waitcnt lgkmcnt(9)
    v_mul_f32 v56, v56, v4
    v_cndmask_b32_dpp v57, v1, v249, vcc row_ror:8 row_mask:0xf bank_mask:0xf
    v_cndmask_b32_dpp v58, v2, v250, vcc row_ror:8 row_mask:0xf bank_mask:0xf
    v_cndmask_b32_dpp v59, v3, v251, vcc row_ror:8 row_mask:0xf bank_mask:0xf
    v_mfma_f32_16x16x32_bf16 v[32:35], v[12:15], v[116:119], v[32:35]
    v_mul_f32 v57, v57, v5
    v_mul_f32 v58, v58, v6
    v_mul_f32 v59, v59, v7
    v_max3_f32 v60, v56, v57, v58
    v_max_f32 v60, v60, v59
    v_mfma_f32_16x16x32_bf16 v[36:39], v[8:11], v[120:123], 0
    ds_swizzle_b32 v61, v60 offset:0x401f
    ds_read_b128 v[8:11], v229 offset:512
    v_cvt_pk_bf16_f32 v148, v24, v25
    v_cvt_pk_bf16_f32 v149, v26, v27
    v_mfma_f32_16x16x32_bf16 v[36:39], v[12:15], v[124:127], v[36:39]
    ds_read_b128 v[12:15], v230 offset:512
    v_cvt_pk_bf16_f32 v156, v28, v29
    v_cvt_pk_bf16_f32 v157, v30, v31
    v_cvt_pk_bf16_f32 v160, v32, v33
    v_mfma_f32_16x16x32_bf16 v[40:43], v[16:19], v[96:99], 0
    v_cvt_pk_bf16_f32 v161, v34, v35
    s_nop 1
    v_cvt_pk_bf16_f32 v164, v36, v37
    v_mfma_f32_16x16x32_bf16 v[40:43], v[20:23], v[100:103], v[40:43]
    v_cvt_pk_bf16_f32 v165, v38, v39
    v_mfma_f32_16x16x32_bf16 v[44:47], v[16:19], v[104:107], 0
    s_waitcnt lgkmcnt(2)
    v_max_f32 v60, v60, v61
    v_mul_f32 v60, v60, v252
    v_fma_f32 v56, v56, v252, -v60
    v_fma_f32 v57, v57, v252, -v60
    v_fma_f32 v58, v58, v252, -v60
    v_mfma_f32_16x16x32_bf16 v[44:47], v[20:23], v[108:111], v[44:47]
    v_fma_f32 v59, v59, v252, -v60
    v_exp_f32 v56, v56
    v_exp_f32 v57, v57
    v_mfma_f32_16x16x32_bf16 v[48:51], v[16:19], v[112:115], 0
    v_exp_f32 v58, v58
    v_exp_f32 v59, v59
    v_add_f32 v62, v56, v57
    v_mfma_f32_16x16x32_bf16 v[48:51], v[20:23], v[116:119], v[48:51]
    v_add_f32 v63, v58, v59
    v_add_f32 v62, v62, v63
    ds_swizzle_b32 v63, v62 offset:0x401f
    v_mul_f32 v56, v56, v4
    v_mul_f32 v57, v57, v5
    v_mfma_f32_16x16x32_bf16 v[52:55], v[16:19], v[120:123], 0
    ds_read_b128 v[16:19], v229 offset:768
    v_mul_f32 v58, v58, v6
    v_mul_f32 v59, v59, v7
    v_cvt_pk_bf16_f32 v168, v40, v41
    v_mfma_f32_16x16x32_bf16 v[52:55], v[20:23], v[124:127], v[52:55]
    ds_read_b128 v[20:23], v230 offset:768
    v_cvt_pk_bf16_f32 v169, v42, v43
    v_cvt_pk_bf16_f32 v172, v44, v45
    v_cvt_pk_bf16_f32 v173, v46, v47
    v_cvt_pk_bf16_f32 v136, v48, v49
    v_cvt_pk_bf16_f32 v137, v50, v51
    ds_read_b128 v[4:7], v242 offset:128
    ds_read_b32 v252, v241 offset:128
    v_cvt_pk_bf16_f32 v140, v52, v53
    v_cvt_pk_bf16_f32 v141, v54, v55
    v_add_u32 v242, s75, v242
    v_add_u32 v241, s75, v241
    s_waitcnt lgkmcnt(4)
    v_add_f32 v62, v62, v63
    v_rcp_f32 v62, v62
    s_nop 0
    v_mul_f32 v56, v56, v62
    v_mul_f32 v57, v57, v62
    v_mul_f32 v58, v58, v62
    v_mul_f32 v59, v59, v62
    v_cvt_pk_bf16_f32 v216, v56, v57
    v_cvt_pk_bf16_f32 v217, v58, v59
    s_nop 0
    v_and_b32_dpp v220, v216, v228 row_ror:8 row_mask:0xf bank_mask:0xf
    v_and_b32 v216, v216, v228
    v_and_b32_dpp v221, v217, v228 row_ror:8 row_mask:0xf bank_mask:0xf
    v_and_b32 v217, v217, v228
    s_nop 0
    v_mfma_f32_16x16x32_bf16 v[40:43], v[168:171], v[220:223], 0
    v_mfma_f32_16x16x32_bf16 v[24:27], v[148:151], v[216:219], 0
    v_mfma_f32_16x16x32_bf16 v[44:47], v[172:175], v[220:223], 0
    v_mfma_f32_16x16x32_bf16 v[28:31], v[156:159], v[216:219], 0
    v_mfma_f32_16x16x32_bf16 v[48:51], v[136:139], v[220:223], 0
    v_mfma_f32_16x16x32_bf16 v[52:55], v[140:143], v[220:223], 0
    v_mfma_f32_16x16x32_bf16 v[32:35], v[160:163], v[216:219], 0
    v_mfma_f32_16x16x32_bf16 v[36:39], v[164:167], v[216:219], 0
    s_nop 0
    v_cvt_pk_bf16_f32 v168, v40, v41
    v_cvt_pk_bf16_f32 v169, v42, v43
    s_waitcnt lgkmcnt(3)
    v_mfma_f32_16x16x32_bf16 v[40:43], v[64:67], v[16:19], 0
    v_cvt_pk_bf16_f32 v148, v24, v25
    v_cvt_pk_bf16_f32 v149, v26, v27
    v_mfma_f32_16x16x32_bf16 v[24:27], v[64:67], v[8:11], 0
    v_cvt_pk_bf16_f32 v150, v28, v29
    v_cvt_pk_bf16_f32 v151, v30, v31
    v_mfma_f32_16x16x32_bf16 v[28:31], v[72:75], v[8:11], 0
    v_cvt_pk_bf16_f32 v170, v44, v45
    v_cvt_pk_bf16_f32 v171, v46, v47
    v_mfma_f32_16x16x32_bf16 v[44:47], v[72:75], v[16:19], 0
    v_cvt_pk_bf16_f32 v156, v32, v33
    v_cvt_pk_bf16_f32 v157, v34, v35
    v_mfma_f32_16x16x32_bf16 v[24:27], v[68:71], v[12:15], v[24:27]
    v_cvt_pk_bf16_f32 v158, v36, v37
    v_cvt_pk_bf16_f32 v159, v38, v39
    v_mfma_f32_16x16x32_bf16 v[28:31], v[76:79], v[12:15], v[28:31]
    v_cvt_pk_bf16_f32 v172, v48, v49
    v_cvt_pk_bf16_f32 v173, v50, v51
    v_mfma_f32_16x16x32_bf16 v[32:35], v[80:83], v[8:11], 0
    v_cvt_pk_bf16_f32 v174, v52, v53
    v_cvt_pk_bf16_f32 v175, v54, v55
    v_mfma_f32_16x16x32_bf16 v[36:39], v[88:91], v[8:11], 0
    v_cvt_pk_bf16_f32 v56, v24, v25
    v_cvt_pk_bf16_f32 v57, v26, v27
    s_waitcnt lgkmcnt(2)
    v_mfma_f32_16x16x32_bf16 v[40:43], v[68:71], v[20:23], v[40:43]
    v_cvt_pk_bf16_f32 v58, v28, v29
    v_cvt_pk_bf16_f32 v59, v30, v31
    v_mfma_f32_16x16x32_bf16 v[44:47], v[76:79], v[20:23], v[44:47]
    ds_write_b64 v236, v[150:151] offset:0
    v_mfma_f32_16x16x32_bf16 v[48:51], v[80:83], v[16:19], 0
    ds_write_b64 v236, v[170:171] offset:256
    v_mfma_f32_16x16x32_bf16 v[52:55], v[88:91], v[16:19], 0
    ds_write_b64 v238, v[158:159] offset:0
    v_mfma_f32_16x16x32_bf16 v[32:35], v[84:87], v[12:15], v[32:35]
    v_cvt_pk_bf16_f32 v128, v40, v41
    v_cvt_pk_bf16_f32 v129, v42, v43
    v_mfma_f32_16x16x32_bf16 v[36:39], v[92:95], v[12:15], v[36:39]
    v_cvt_pk_bf16_f32 v130, v44, v45
    v_cvt_pk_bf16_f32 v131, v46, v47
    v_mfma_f32_16x16x32_bf16 v[48:51], v[84:87], v[20:23], v[48:51]
    ds_write_b64 v238, v[174:175] offset:256
    v_mfma_f32_16x16x32_bf16 v[52:55], v[92:95], v[20:23], v[52:55]
    v_cvt_pk_bf16_f32 v60, v32, v33
    v_cvt_pk_bf16_f32 v61, v34, v35
    v_mfma_f32_16x16x32_bf16 v[248:251], v[8:11], v[56:59], 0
    v_cvt_pk_bf16_f32 v62, v36, v37
    v_cvt_pk_bf16_f32 v63, v38, v39
    v_mfma_f32_16x16x32_bf16 v[0:3], v[16:19], v[128:131], 0
    v_cvt_pk_bf16_f32 v132, v48, v49
    v_cvt_pk_bf16_f32 v133, v50, v51
    v_mfma_f32_16x16x32_bf16 v[248:251], v[12:15], v[60:63], v[248:251]
    v_cvt_pk_bf16_f32 v134, v52, v53
    v_cvt_pk_bf16_f32 v135, v54, v55
    v_mfma_f32_16x16x32_bf16 v[160:163], v[148:151], v[148:151], 0
    ds_write_b64 v235, v[148:149] offset:0
    v_mfma_f32_16x16x32_bf16 v[0:3], v[20:23], v[132:135], v[0:3]
    ds_write_b64 v235, v[168:169] offset:256
    v_mfma_f32_16x16x32_bf16 v[24:27], v[8:11], v[96:99], 0
    ds_write_b64 v237, v[156:157] offset:0
    v_mfma_f32_16x16x32_bf16 v[136:139], v[168:171], v[168:171], 0
    ds_write_b64 v237, v[172:173] offset:256
    v_mfma_f32_16x16x32_bf16 v[24:27], v[12:15], v[100:103], v[24:27]
    s_nop 1
    v_cndmask_b32_dpp v56, v0, v248, vcc row_ror:8 row_mask:0xf bank_mask:0xf
    v_mfma_f32_16x16x32_bf16 v[164:167], v[208:211], v[148:151], 0
    v_cndmask_b32_dpp v57, v1, v249, vcc row_ror:8 row_mask:0xf bank_mask:0xf
    v_cndmask_b32_dpp v58, v2, v250, vcc row_ror:8 row_mask:0xf bank_mask:0xf
    v_mfma_f32_16x16x32_bf16 v[28:31], v[8:11], v[104:107], 0
    v_cndmask_b32_dpp v59, v3, v251, vcc row_ror:8 row_mask:0xf bank_mask:0xf
    s_waitcnt lgkmcnt(9)
    v_mul_f32 v56, v56, v4
    v_mfma_f32_16x16x32_bf16 v[140:143], v[208:211], v[168:171], 0
    v_mul_f32 v57, v57, v5
    v_mul_f32 v58, v58, v6
    v_mfma_f32_16x16x32_bf16 v[28:31], v[12:15], v[108:111], v[28:31]
    v_mul_f32 v59, v59, v7
    v_max3_f32 v60, v56, v57, v58
    v_mfma_f32_16x16x32_bf16 v[160:163], v[156:159], v[156:159], v[160:163]
    v_max_f32 v60, v60, v59
    ds_swizzle_b32 v61, v60 offset:0x401f
    v_mfma_f32_16x16x32_bf16 v[32:35], v[8:11], v[112:115], 0
    ds_read_b64_tr_b16 v[150:151], v231 offset:512
    ds_read_b64_tr_b16 v[170:171], v231 offset:768
    v_mfma_f32_16x16x32_bf16 v[136:139], v[172:175], v[172:175], v[136:139]
    v_cvt_pk_bf16_f32 v148, v24, v25
    v_cvt_pk_bf16_f32 v149, v26, v27
    v_mfma_f32_16x16x32_bf16 v[32:35], v[12:15], v[116:119], v[32:35]
    v_cndmask_b32 v160, v160, v161, s[88:89]
    v_cndmask_b32 v162, v162, v163, s[88:89]
    v_mfma_f32_16x16x32_bf16 v[164:167], v[212:215], v[156:159], v[164:167]
    ds_read_b64_tr_b16 v[158:159], v232 offset:512
    v_cndmask_b32 v160, v160, v162, s[90:91]
    v_mfma_f32_16x16x32_bf16 v[36:39], v[8:11], v[120:123], 0
    v_cndmask_b32 v136, v136, v137, s[88:89]
    v_cndmask_b32 v138, v138, v139, s[88:89]
    v_mfma_f32_16x16x32_bf16 v[140:143], v[212:215], v[172:175], v[140:143]
    ds_read_b64_tr_b16 v[174:175], v232 offset:768
    v_cndmask_b32 v136, v136, v138, s[90:91]
    v_mfma_f32_16x16x32_bf16 v[36:39], v[12:15], v[124:127], v[36:39]
    ds_read_b64_tr_b16 v[162:163], v233 offset:512
    s_waitcnt lgkmcnt(5)
    v_max_f32 v60, v60, v61
    v_mul_f32 v60, v60, v252
    v_fma_f32 v56, v56, v252, -v60
    v_fma_f32 v57, v57, v252, -v60
    v_mfma_f32_16x16x32_bf16 v[40:43], v[16:19], v[96:99], 0
    v_fma_f32 v58, v58, v252, -v60
    v_fma_f32 v59, v59, v252, -v60
    v_exp_f32 v56, v56
    v_exp_f32 v57, v57
    v_mfma_f32_16x16x32_bf16 v[40:43], v[20:23], v[100:103], v[40:43]
    v_exp_f32 v58, v58
    v_exp_f32 v59, v59
    v_add_f32 v62, v56, v57
    v_mfma_f32_16x16x32_bf16 v[44:47], v[16:19], v[104:107], 0
    v_add_f32 v63, v58, v59
    v_add_f32 v62, v62, v63
    ds_swizzle_b32 v63, v62 offset:0x401f
    ds_read_b64_tr_b16 v[166:167], v234 offset:512
    ds_read_b64_tr_b16 v[138:139], v233 offset:768
    v_mfma_f32_16x16x32_bf16 v[44:47], v[20:23], v[108:111], v[44:47]
    ds_read_b64_tr_b16 v[142:143], v234 offset:768
    v_mul_f32 v56, v56, v4
    v_mul_f32 v57, v57, v5
    v_mul_f32 v58, v58, v6
    v_mul_f32 v59, v59, v7
    v_mfma_f32_16x16x32_bf16 v[48:51], v[16:19], v[112:115], 0
    v_cvt_pk_bf16_f32 v168, v40, v41
    v_cvt_pk_bf16_f32 v169, v42, v43
    v_cvt_pk_bf16_f32 v156, v28, v29
    v_cvt_pk_bf16_f32 v157, v30, v31
    v_cvt_pk_bf16_f32 v172, v44, v45
    v_mfma_f32_16x16x32_bf16 v[48:51], v[20:23], v[116:119], v[48:51]
    v_cvt_pk_bf16_f32 v173, v46, v47
    v_mov_b32 v254, v164
    v_mov_b32 v255, v165
    s_mov_b64 exec, s[92:93]
    ds_write_b32 v225, v160 offset:0
    s_mov_b64 exec, -1
    s_mov_b64 exec, s[92:93]
    ds_write_b32 v225, v136 offset:64
    s_mov_b64 exec, -1
    v_mfma_f32_16x16x32_bf16 v[52:55], v[16:19], v[120:123], 0
    v_cndmask_b32 v254, v254, v140, s[94:95]
    v_cndmask_b32 v255, v255, v141, s[94:95]
    s_waitcnt lgkmcnt(5)
    v_add_f32 v62, v62, v63
    v_rcp_f32 v62, v62
    v_mfma_f32_16x16x32_bf16 v[52:55], v[20:23], v[124:127], v[52:55]
    v_mul_f32 v56, v56, v62
    v_mul_f32 v57, v57, v62
    v_mul_f32 v58, v58, v62
    v_mul_f32 v59, v59, v62
    v_cvt_pk_bf16_f32 v216, v56, v57
    v_cvt_pk_bf16_f32 v217, v58, v59
    v_cvt_pk_bf16_f32 v160, v32, v33
    v_and_b32_dpp v220, v216, v228 row_ror:8 row_mask:0xf bank_mask:0xf
    v_and_b32_dpp v221, v217, v228 row_ror:8 row_mask:0xf bank_mask:0xf
    v_and_b32 v216, v216, v228
    v_and_b32 v217, v217, v228
    v_mfma_f32_16x16x32_bf16 v[40:43], v[168:171], v[220:223], 0
    v_cvt_pk_bf16_f32 v161, v34, v35
    v_cvt_pk_bf16_f32 v164, v36, v37
    v_mfma_f32_16x16x32_bf16 v[24:27], v[148:151], v[216:219], 0
    v_cvt_pk_bf16_f32 v165, v38, v39
    v_cvt_pk_bf16_f32 v136, v48, v49
    v_mfma_f32_16x16x32_bf16 v[28:31], v[156:159], v[216:219], 0
    v_cvt_pk_bf16_f32 v137, v50, v51
    v_cvt_pk_bf16_f32 v140, v52, v53
    v_mfma_f32_16x16x32_bf16 v[44:47], v[172:175], v[220:223], 0
    v_cvt_pk_bf16_f32 v141, v54, v55
    v_cvt_pk_bf16_f32 v168, v40, v41
    v_mfma_f32_16x16x32_bf16 v[32:35], v[160:163], v[216:219], 0
    v_cvt_pk_bf16_f32 v148, v24, v25
    v_cvt_pk_bf16_f32 v149, v26, v27
    s_waitcnt lgkmcnt(4)
    v_mfma_f32_16x16x32_bf16 v[36:39], v[164:167], v[216:219], 0
    v_cvt_pk_bf16_f32 v150, v28, v29
    v_cvt_pk_bf16_f32 v151, v30, v31
    s_waitcnt lgkmcnt(3)
    v_mfma_f32_16x16x32_bf16 v[48:51], v[136:139], v[220:223], 0
    v_cvt_pk_bf16_f32 v169, v42, v43
    v_cvt_pk_bf16_f32 v170, v44, v45
    s_waitcnt lgkmcnt(2)
    v_mfma_f32_16x16x32_bf16 v[52:55], v[140:143], v[220:223], 0
    v_cvt_pk_bf16_f32 v171, v46, v47
    v_cvt_pk_bf16_f32 v156, v32, v33
    v_mfma_f32_16x16x32_bf16 v[160:163], v[148:151], v[148:151], 0
    v_cvt_pk_bf16_f32 v157, v34, v35
    v_cvt_pk_bf16_f32 v158, v36, v37
    v_mfma_f32_16x16x32_bf16 v[136:139], v[168:171], v[168:171], 0
    v_cvt_pk_bf16_f32 v159, v38, v39
    v_cvt_pk_bf16_f32 v172, v48, v49
    v_mfma_f32_16x16x32_bf16 v[164:167], v[208:211], v[148:151], 0
    v_cvt_pk_bf16_f32 v173, v50, v51
    v_cvt_pk_bf16_f32 v174, v52, v53
    v_mfma_f32_16x16x32_bf16 v[160:163], v[156:159], v[156:159], v[160:163]
    v_cvt_pk_bf16_f32 v175, v54, v55
    ds_write_b64 v235, v[148:149] offset:512
    v_mfma_f32_16x16x32_bf16 v[140:143], v[208:211], v[168:171], 0
    ds_write_b64 v236, v[150:151] offset:512
    v_mfma_f32_16x16x32_bf16 v[136:139], v[172:175], v[172:175], v[136:139]
    ds_write_b64 v237, v[156:157] offset:512
    v_mfma_f32_16x16x32_bf16 v[164:167], v[212:215], v[156:159], v[164:167]
    ds_write_b64 v238, v[158:159] offset:512
    v_mfma_f32_16x16x32_bf16 v[140:143], v[212:215], v[172:175], v[140:143]
    v_cndmask_b32 v160, v160, v161, s[88:89]
    v_cndmask_b32 v162, v162, v163, s[88:89]
    v_cndmask_b32 v160, v160, v162, s[90:91]
    s_mov_b64 exec, s[92:93]
    ds_write_b32 v225, v160 offset:128
    s_mov_b64 exec, -1
    v_cndmask_b32 v136, v136, v137, s[88:89]
    v_cndmask_b32 v138, v138, v139, s[88:89]
    v_cndmask_b32 v136, v136, v138, s[90:91]
    s_mov_b64 exec, s[92:93]
    ds_write_b32 v225, v136 offset:192
    s_mov_b64 exec, -1
    ds_read_b32 v224, v227
    v_cndmask_b32 v254, v254, v164, s[28:29]
    ds_write_b64 v235, v[168:169] offset:768
    ds_write_b64 v236, v[170:171] offset:768
    ds_write_b64 v237, v[172:173] offset:768
    ds_write_b64 v238, v[174:175] offset:768
    v_cndmask_b32 v254, v254, v140, s[30:31]
    v_xor_b32 v227, 32, v239
    v_mul_f32 v254, v254, v254
    ds_read_b64_tr_b16 v[156:157], v227 offset:0
    ds_read_b64_tr_b16 v[172:173], v227 offset:512
    v_xor_b32 v227, 32, v240
    ds_read_b64_tr_b16 v[158:159], v227 offset:0
    ds_read_b64_tr_b16 v[174:175], v227 offset:512
    v_xor_b32 v227, 64, v239
    v_cndmask_b32 v255, v255, v165, s[28:29]
    ds_read_b64_tr_b16 v[160:161], v227 offset:0
    ds_read_b64_tr_b16 v[136:137], v227 offset:512
    v_cndmask_b32 v255, v255, v141, s[30:31]
    v_xor_b32 v227, 64, v240
    ds_read_b64_tr_b16 v[162:163], v227 offset:0
    ds_read_b64_tr_b16 v[138:139], v227 offset:512
    v_xor_b32 v227, 96, v239
    ds_read_b64_tr_b16 v[164:165], v227 offset:0
    s_waitcnt lgkmcnt(13)
    v_fma_f32 v254, v224, s74, -v254
    v_max_f32 v254, 0, v254
    v_add_f32 v254, 0x3d27c5ac, v254
    v_rsq_f32 v254, v254
    ds_read_b64_tr_b16 v[140:141], v227 offset:512
    v_mul_f32 v254, v254, v255
    v_xor_b32 v227, 96, v240
    ds_read_b64_tr_b16 v[166:167], v227 offset:0
    v_max_f32_dpp v224, v254, v254 quad_perm:[1,0,3,2] row_mask:0xf bank_mask:0xf
    ds_read_b64_tr_b16 v[142:143], v227 offset:512
    v_mov_b32 v227, s6
    v_max_f32_dpp v224, v224, v224 quad_perm:[2,3,0,1] row_mask:0xf bank_mask:0xf
    v_cndmask_b32 v227, 0, v227, s[32:33]
    ds_read_b32 v252, v226
    v_max_f32_dpp v224, v224, v224 row_half_mirror row_mask:0xf bank_mask:0xf
    v_sub_f32 v254, v254, v224
    v_add_u32 v229, v227, v229
    v_add_u32 v230, v227, v230
    v_add_u32 v235, v227, v235
    v_add_u32 v236, v227, v236
    v_add_u32 v237, v227, v237
    v_add_u32 v238, v227, v238
    v_exp_f32 v254, v254
    v_mov_b32 v227, s6
    v_cndmask_b32 v227, 0, v227, s[34:35]
    v_add_u32 v231, v227, v231
    v_add_u32 v232, v227, v232
    v_add_u32 v233, v227, v233
    v_add_u32 v234, v227, v234
    v_add_f32_dpp v224, v254, v254 quad_perm:[1,0,3,2] row_mask:0xf bank_mask:0xf
    v_mov_b32 v227, s6
    ds_read_b64_tr_b16 v[148:149], v239 offset:0
    ds_read_b64_tr_b16 v[168:169], v239 offset:512
    v_cndmask_b32 v227, 0, v227, s[60:61]
    v_add_f32_dpp v224, v224, v224 quad_perm:[2,3,0,1] row_mask:0xf bank_mask:0xf
    v_add_u32 v239, v227, v239
    ds_read_b64_tr_b16 v[150:151], v240 offset:0
    ds_read_b64_tr_b16 v[170:171], v240 offset:512
    v_xor_b32 v227, 160, v247
    v_add_f32_dpp v224, v224, v224 row_half_mirror row_mask:0xf bank_mask:0xf
    s_setprio 1
    ds_write_b128 v227, v[176:179] offset:0
    v_rcp_f32 v224, v224
    v_xor_b32 v227, 64, v247
    v_mul_f32 v254, v254, v224
    v_cvt_pk_bf16_f32 v254, v254, v254
    ds_write_b128 v227, v[180:183] offset:1024
    ds_write_b16 v243, v254
    v_and_b32 v254, 0xffff0000, v254
    s_waitcnt lgkmcnt(7)
    v_lshlrev_b32 v252, 16, v252
    v_xor_b32 v227, 192, v247
    v_mul_f32 v254, v254, v252
    ds_write_b128 v227, v[184:187] offset:2048
    v_xor_b32 v227, 96, v247
    v_add_f32_dpp v254, v254, v254 quad_perm:[1,0,3,2] row_mask:0xf bank_mask:0xf
    ds_write_b128 v227, v[188:191] offset:3072
    v_lshlrev_b32 v224, 3, v225
    v_add_f32_dpp v254, v254, v254 quad_perm:[2,3,0,1] row_mask:0xf bank_mask:0xf
    v_xor_b32 v227, 224, v247
    ds_write_b128 v227, v[144:147] offset:4096
    v_add_f32_dpp v254, v254, v254 row_half_mirror row_mask:0xf bank_mask:0xf
    ds_bpermute_b32 v24, v224, v254
    ds_read_b128 v[28:31], v244
    ds_read_b128 v[8:11], v229 offset:0
    ds_read_b128 v[16:19], v229 offset:256
    ds_read_b128 v[32:35], v245
    ds_read_b128 v[12:15], v230 offset:0
    ds_read_b128 v[20:23], v230 offset:256
    ds_read_b128 v[4:7], v242 offset:0
    ds_read_b32 v252, v241 offset:0
    ds_read_b32 v255, v246
    v_lshl_add_u32 v227, v243, 1, s72
    v_add_u32 v240, s68, v240
    v_add_u32 v226, s75, v226
    v_add_u32 v246, s40, v246
    s_waitcnt lgkmcnt(9)
    v_mov_b32 v25, v24
    v_mov_b32 v26, v24
    v_mov_b32 v27, v24
    s_waitcnt lgkmcnt(7)
    v_mfma_f32_16x16x32_bf16 v[36:39], v[64:67], v[8:11], 0
    v_mfma_f32_16x16x32_bf16 v[248:251], v[148:151], v[28:31], v[24:27]
    v_mfma_f32_16x16x32_bf16 v[0:3], v[156:159], v[28:31], v[24:27]
    ds_read_b64_tr_b16 v[158:159], v232 offset:0
    v_mfma_f32_16x16x32_bf16 v[56:59], v[160:163], v[28:31], v[24:27]
    s_waitcnt lgkmcnt(1)
    v_or_b32 v255, v255, v253
    ds_read_b64_tr_b16 v[162:163], v233 offset:0
    v_mfma_f32_16x16x32_bf16 v[60:63], v[164:167], v[28:31], v[24:27]
    ds_read_b64_tr_b16 v[166:167], v234 offset:0
    v_mfma_f32_16x16x32_bf16 v[40:43], v[72:75], v[8:11], 0
    v_mfma_f32_16x16x32_bf16 v[52:55], v[64:67], v[16:19], 0
    v_mfma_f32_16x16x32_bf16 v[24:27], v[72:75], v[16:19], 0
    v_mfma_f32_16x16x32_bf16 v[248:251], v[168:171], v[32:35], v[248:251]
    ds_read_b64_tr_b16 v[170:171], v231 offset:256
    v_mfma_f32_16x16x32_bf16 v[0:3], v[172:175], v[32:35], v[0:3]
    ds_read_b64_tr_b16 v[174:175], v232 offset:256
    v_mfma_f32_16x16x32_bf16 v[56:59], v[136:139], v[32:35], v[56:59]
    ds_read_b64_tr_b16 v[138:139], v233 offset:256
    v_mfma_f32_16x16x32_bf16 v[60:63], v[140:143], v[32:35], v[60:63]
    ds_read_b64_tr_b16 v[142:143], v234 offset:256
    v_mfma_f32_16x16x32_bf16 v[44:47], v[80:83], v[8:11], 0
    v_mfma_f32_16x16x32_bf16 v[48:51], v[88:91], v[8:11], 0
    v_mfma_f32_16x16x32_bf16 v[36:39], v[68:71], v[12:15], v[36:39]
    v_mfma_f32_16x16x32_bf16 v[28:31], v[80:83], v[16:19], 0
    s_nop 0
    v_cndmask_b32 v248, v248, v56, s[78:79]
    v_mfma_f32_16x16x32_bf16 v[40:43], v[76:79], v[12:15], v[40:43]
    v_cndmask_b32 v249, v249, v57, s[78:79]
    v_cndmask_b32 v250, v250, v58, s[78:79]
    v_mfma_f32_16x16x32_bf16 v[52:55], v[68:71], v[20:23], v[52:55]
    v_cndmask_b32 v251, v251, v59, s[78:79]
    v_cndmask_b32 v0, v0, v60, s[78:79]
    v_mfma_f32_16x16x32_bf16 v[24:27], v[76:79], v[20:23], v[24:27]
    v_cndmask_b32 v1, v1, v61, s[78:79]
    v_cndmask_b32 v2, v2, v62, s[78:79]
    v_mfma_f32_16x16x32_bf16 v[32:35], v[88:91], v[16:19], 0
    v_cndmask_b32 v3, v3, v63, s[78:79]
    v_cvt_pk_bf16_f32 v56, v36, v37
    v_mfma_f32_16x16x32_bf16 v[44:47], v[84:87], v[12:15], v[44:47]
    v_cvt_pk_bf16_f32 v57, v38, v39
    v_cvt_pk_bf16_f32 v58, v40, v41
    v_mfma_f32_16x16x32_bf16 v[48:51], v[92:95], v[12:15], v[48:51]
    v_cvt_pk_bf16_f32 v59, v42, v43
    v_cvt_pk_bf16_f32 v128, v52, v53
    v_mfma_f32_16x16x32_bf16 v[28:31], v[84:87], v[20:23], v[28:31]
    v_cvt_pk_bf16_f32 v129, v54, v55
    v_cvt_pk_bf16_f32 v130, v24, v25
    v_mfma_f32_16x16x32_bf16 v[32:35], v[92:95], v[20:23], v[32:35]
    v_cvt_pk_bf16_f32 v131, v26, v27
    v_cvt_pk_bf16_f32 v148, v248, v249
    v_cvt_pk_bf16_f32 v149, v250, v251
    v_mfma_f32_16x16x32_bf16 v[248:251], v[8:11], v[56:59], 0
    v_cvt_pk_bf16_f32 v150, v0, v1
    v_cvt_pk_bf16_f32 v151, v2, v3
    v_mfma_f32_16x16x32_bf16 v[0:3], v[16:19], v[128:131], 0
    v_cvt_pk_bf16_f32 v60, v44, v45
    v_cvt_pk_bf16_f32 v61, v46, v47
    v_cvt_pk_bf16_f32 v62, v48, v49
    v_cvt_pk_bf16_f32 v63, v50, v51
    v_cvt_pk_bf16_f32 v132, v28, v29
    v_cvt_pk_bf16_f32 v133, v30, v31
    v_mfma_f32_16x16x32_bf16 v[248:251], v[12:15], v[60:63], v[248:251]
    v_cvt_pk_bf16_f32 v134, v32, v33
    v_cvt_pk_bf16_f32 v135, v34, v35
    v_permlane16_swap_b32 v148, v150
    v_permlane16_swap_b32 v149, v151
    v_mfma_f32_16x16x32_bf16 v[0:3], v[20:23], v[132:135], v[0:3]
    buffer_store_dwordx4 v[148:151], v255, s[20:23], 0 offen sc1
    v_mfma_f32_16x16x32_bf16 v[36:39], v[8:11], v[96:99], 0
    ds_read_b64_tr_b16 v[150:151], v231 offset:0
    v_mfma_f32_16x16x32_bf16 v[36:39], v[12:15], v[100:103], v[36:39]
    s_nop 3
    v_cndmask_b32_dpp v56, v0, v248, vcc row_ror:8 row_mask:0xf bank_mask:0xf
    v_mfma_f32_16x16x32_bf16 v[40:43], v[8:11], v[104:107], 0
    v_mul_f32 v56, v56, v4
    v_cndmask_b32_dpp v57, v1, v249, vcc row_ror:8 row_mask:0xf bank_mask:0xf
    v_cndmask_b32_dpp v58, v2, v250, vcc row_ror:8 row_mask:0xf bank_mask:0xf
    v_cndmask_b32_dpp v59, v3, v251, vcc row_ror:8 row_mask:0xf bank_mask:0xf
    v_mfma_f32_16x16x32_bf16 v[40:43], v[12:15], v[108:111], v[40:43]
    v_mul_f32 v57, v57, v5
    v_mul_f32 v58, v58, v6
    v_mul_f32 v59, v59, v7
    v_max3_f32 v60, v56, v57, v58
    v_max_f32 v60, v60, v59
    v_mfma_f32_16x16x32_bf16 v[44:47], v[8:11], v[112:115], 0
    ds_swizzle_b32 v61, v60 offset:0x401f
    v_cvt_pk_bf16_f32 v148, v36, v37
    v_cvt_pk_bf16_f32 v149, v38, v39
    v_cvt_pk_bf16_f32 v156, v40, v41
    v_cvt_pk_bf16_f32 v157, v42, v43
    v_mfma_f32_16x16x32_bf16 v[44:47], v[12:15], v[116:119], v[44:47]
    v_mfma_f32_16x16x32_bf16 v[48:51], v[8:11], v[120:123], 0
    ds_read_b128 v[8:11], v229 offset:512
    v_mfma_f32_16x16x32_bf16 v[48:51], v[12:15], v[124:127], v[48:51]
    ds_read_b128 v[12:15], v230 offset:512
    v_mfma_f32_16x16x32_bf16 v[52:55], v[16:19], v[96:99], 0
    s_waitcnt lgkmcnt(2)
    v_max_f32 v60, v60, v61
    v_mul_f32 v60, v60, v252
    v_fma_f32 v56, v56, v252, -v60
    v_fma_f32 v57, v57, v252, -v60
    v_fma_f32 v58, v58, v252, -v60
    v_mfma_f32_16x16x32_bf16 v[52:55], v[20:23], v[100:103], v[52:55]
    v_fma_f32 v59, v59, v252, -v60
    v_exp_f32 v56, v56
    v_exp_f32 v57, v57
    v_mfma_f32_16x16x32_bf16 v[24:27], v[16:19], v[104:107], 0
    v_exp_f32 v58, v58
    v_exp_f32 v59, v59
    v_add_f32 v62, v56, v57
    v_mfma_f32_16x16x32_bf16 v[24:27], v[20:23], v[108:111], v[24:27]
    v_add_f32 v63, v58, v59
    v_add_f32 v62, v62, v63
    ds_swizzle_b32 v63, v62 offset:0x401f
    v_mul_f32 v56, v56, v4
    v_mul_f32 v57, v57, v5
    v_mfma_f32_16x16x32_bf16 v[28:31], v[16:19], v[112:115], 0
    v_mul_f32 v58, v58, v6
    v_mul_f32 v59, v59, v7
    v_cvt_pk_bf16_f32 v168, v52, v53
    v_cvt_pk_bf16_f32 v169, v54, v55
    v_cvt_pk_bf16_f32 v172, v24, v25
    v_mfma_f32_16x16x32_bf16 v[28:31], v[20:23], v[116:119], v[28:31]
    v_cvt_pk_bf16_f32 v173, v26, v27
    v_cvt_pk_bf16_f32 v160, v44, v45
    v_cvt_pk_bf16_f32 v161, v46, v47
    v_cvt_pk_bf16_f32 v164, v48, v49
    v_cvt_pk_bf16_f32 v165, v50, v51
    v_mfma_f32_16x16x32_bf16 v[32:35], v[16:19], v[120:123], 0
    ds_read_b128 v[16:19], v229 offset:768
    ds_read_b128 v[4:7], v242 offset:128
    v_cvt_pk_bf16_f32 v136, v28, v29
    v_mfma_f32_16x16x32_bf16 v[32:35], v[20:23], v[124:127], v[32:35]
    ds_read_b128 v[20:23], v230 offset:768
    s_waitcnt lgkmcnt(3)
    v_add_f32 v62, v62, v63
    v_rcp_f32 v62, v62
    v_cvt_pk_bf16_f32 v137, v30, v31
    v_mul_f32 v56, v56, v62
    v_mul_f32 v57, v57, v62
    v_mul_f32 v58, v58, v62
    v_mul_f32 v59, v59, v62
    v_cvt_pk_bf16_f32 v216, v56, v57
    v_cvt_pk_bf16_f32 v217, v58, v59
    v_cvt_pk_bf16_f32 v140, v32, v33
    v_and_b32_dpp v220, v216, v228 row_ror:8 row_mask:0xf bank_mask:0xf
    v_and_b32_dpp v221, v217, v228 row_ror:8 row_mask:0xf bank_mask:0xf
    v_and_b32 v216, v216, v228
    v_and_b32 v217, v217, v228
    v_mfma_f32_16x16x32_bf16 v[52:55], v[168:171], v[220:223], 0
    v_cvt_pk_bf16_f32 v141, v34, v35
    ds_read_b32 v252, v241 offset:128
    v_mfma_f32_16x16x32_bf16 v[36:39], v[148:151], v[216:219], 0
    v_add_u32 v242, s75, v242
    v_add_u32 v241, s75, v241
    v_mfma_f32_16x16x32_bf16 v[40:43], v[156:159], v[216:219], 0
    v_mfma_f32_16x16x32_bf16 v[24:27], v[172:175], v[220:223], 0
    s_nop 0
    v_cvt_pk_bf16_f32 v168, v52, v53
    v_mfma_f32_16x16x32_bf16 v[44:47], v[160:163], v[216:219], 0
    v_cvt_pk_bf16_f32 v169, v54, v55
    ds_write_b64 v235, v[168:169] offset:256
    v_mfma_f32_16x16x32_bf16 v[48:51], v[164:167], v[216:219], 0
    v_cvt_pk_bf16_f32 v148, v36, v37
    v_cvt_pk_bf16_f32 v149, v38, v39
    v_mfma_f32_16x16x32_bf16 v[28:31], v[136:139], v[220:223], 0
    v_cvt_pk_bf16_f32 v150, v40, v41
    v_cvt_pk_bf16_f32 v151, v42, v43
    v_mfma_f32_16x16x32_bf16 v[32:35], v[140:143], v[220:223], 0
    v_cvt_pk_bf16_f32 v170, v24, v25
    v_cvt_pk_bf16_f32 v171, v26, v27
    v_mfma_f32_16x16x32_bf16 v[36:39], v[64:67], v[8:11], 0
    v_cvt_pk_bf16_f32 v156, v44, v45
    v_cvt_pk_bf16_f32 v157, v46, v47
    v_mfma_f32_16x16x32_bf16 v[40:43], v[72:75], v[8:11], 0
    v_cvt_pk_bf16_f32 v158, v48, v49
    v_cvt_pk_bf16_f32 v159, v50, v51
    s_waitcnt lgkmcnt(4)
    v_mfma_f32_16x16x32_bf16 v[52:55], v[64:67], v[16:19], 0
    v_cvt_pk_bf16_f32 v172, v28, v29
    v_cvt_pk_bf16_f32 v173, v30, v31
    v_mfma_f32_16x16x32_bf16 v[24:27], v[72:75], v[16:19], 0
    v_cvt_pk_bf16_f32 v174, v32, v33
    v_cvt_pk_bf16_f32 v175, v34, v35
    v_mfma_f32_16x16x32_bf16 v[36:39], v[68:71], v[12:15], v[36:39]
    ds_write_b64 v236, v[150:151] offset:0
    v_mfma_f32_16x16x32_bf16 v[40:43], v[76:79], v[12:15], v[40:43]
    ds_write_b64 v236, v[170:171] offset:256
    v_mfma_f32_16x16x32_bf16 v[44:47], v[80:83], v[8:11], 0
    ds_write_b64 v238, v[158:159] offset:0
    v_mfma_f32_16x16x32_bf16 v[48:51], v[88:91], v[8:11], 0
    ds_write_b64 v238, v[174:175] offset:256
    s_waitcnt lgkmcnt(6)
    v_mfma_f32_16x16x32_bf16 v[52:55], v[68:71], v[20:23], v[52:55]
    v_cvt_pk_bf16_f32 v56, v36, v37
    v_cvt_pk_bf16_f32 v57, v38, v39
    v_mfma_f32_16x16x32_bf16 v[24:27], v[76:79], v[20:23], v[24:27]
    v_cvt_pk_bf16_f32 v58, v40, v41
    v_cvt_pk_bf16_f32 v59, v42, v43
    v_mfma_f32_16x16x32_bf16 v[28:31], v[80:83], v[16:19], 0
    ds_write_b64 v235, v[148:149] offset:0
    v_mfma_f32_16x16x32_bf16 v[32:35], v[88:91], v[16:19], 0
    v_cvt_pk_bf16_f32 v128, v52, v53
    v_cvt_pk_bf16_f32 v129, v54, v55
    v_mfma_f32_16x16x32_bf16 v[44:47], v[84:87], v[12:15], v[44:47]
    v_cvt_pk_bf16_f32 v130, v24, v25
    v_cvt_pk_bf16_f32 v131, v26, v27
    v_mfma_f32_16x16x32_bf16 v[48:51], v[92:95], v[12:15], v[48:51]
    ds_write_b64 v237, v[156:157] offset:0
    v_mfma_f32_16x16x32_bf16 v[28:31], v[84:87], v[20:23], v[28:31]
    ds_write_b64 v237, v[172:173] offset:256
    v_mfma_f32_16x16x32_bf16 v[32:35], v[92:95], v[20:23], v[32:35]
    s_nop 0
    v_cvt_pk_bf16_f32 v60, v44, v45
    v_mfma_f32_16x16x32_bf16 v[248:251], v[8:11], v[56:59], 0
    v_cvt_pk_bf16_f32 v61, v46, v47
    v_mfma_f32_16x16x32_bf16 v[0:3], v[16:19], v[128:131], 0
    v_cvt_pk_bf16_f32 v62, v48, v49
    v_cvt_pk_bf16_f32 v63, v50, v51
    v_mfma_f32_16x16x32_bf16 v[160:163], v[148:151], v[148:151], 0
    v_cvt_pk_bf16_f32 v132, v28, v29
    v_cvt_pk_bf16_f32 v133, v30, v31
    v_mfma_f32_16x16x32_bf16 v[248:251], v[12:15], v[60:63], v[248:251]
    v_cvt_pk_bf16_f32 v134, v32, v33
    v_cvt_pk_bf16_f32 v135, v34, v35
    v_mfma_f32_16x16x32_bf16 v[136:139], v[168:171], v[168:171], 0
    s_nop 0
    v_mfma_f32_16x16x32_bf16 v[0:3], v[20:23], v[132:135], v[0:3]
    v_mfma_f32_16x16x32_bf16 v[36:39], v[8:11], v[96:99], 0
    v_mfma_f32_16x16x32_bf16 v[164:167], v[208:211], v[148:151], 0
    ds_read_b64_tr_b16 v[150:151], v231 offset:512
    v_mfma_f32_16x16x32_bf16 v[36:39], v[12:15], v[100:103], v[36:39]
    v_mfma_f32_16x16x32_bf16 v[140:143], v[208:211], v[168:171], 0
    ds_read_b64_tr_b16 v[170:171], v231 offset:768
    v_mfma_f32_16x16x32_bf16 v[40:43], v[8:11], v[104:107], 0
    s_nop 0
    v_cndmask_b32_dpp v56, v0, v248, vcc row_ror:8 row_mask:0xf bank_mask:0xf
    v_mfma_f32_16x16x32_bf16 v[160:163], v[156:159], v[156:159], v[160:163]
    v_cndmask_b32_dpp v57, v1, v249, vcc row_ror:8 row_mask:0xf bank_mask:0xf
    v_cndmask_b32_dpp v58, v2, v250, vcc row_ror:8 row_mask:0xf bank_mask:0xf
    v_mfma_f32_16x16x32_bf16 v[40:43], v[12:15], v[108:111], v[40:43]
    v_cndmask_b32_dpp v59, v3, v251, vcc row_ror:8 row_mask:0xf bank_mask:0xf
    v_mul_f32 v56, v56, v4
    v_mfma_f32_16x16x32_bf16 v[136:139], v[172:175], v[172:175], v[136:139]
    v_mul_f32 v57, v57, v5
    v_mul_f32 v58, v58, v6
    v_mfma_f32_16x16x32_bf16 v[44:47], v[8:11], v[112:115], 0
    v_mul_f32 v59, v59, v7
    v_max3_f32 v60, v56, v57, v58
    v_mfma_f32_16x16x32_bf16 v[164:167], v[212:215], v[156:159], v[164:167]
    v_max_f32 v60, v60, v59
    ds_swizzle_b32 v61, v60 offset:0x401f
    v_mfma_f32_16x16x32_bf16 v[44:47], v[12:15], v[116:119], v[44:47]
    ds_read_b64_tr_b16 v[158:159], v232 offset:512
    v_cndmask_b32 v160, v160, v161, s[88:89]
    v_mfma_f32_16x16x32_bf16 v[140:143], v[212:215], v[172:175], v[140:143]
    ds_read_b64_tr_b16 v[174:175], v232 offset:768
    v_cndmask_b32 v162, v162, v163, s[88:89]
    v_mfma_f32_16x16x32_bf16 v[48:51], v[8:11], v[120:123], 0
    v_cndmask_b32 v136, v136, v137, s[88:89]
    v_cndmask_b32 v138, v138, v139, s[88:89]
    v_cndmask_b32 v160, v160, v162, s[90:91]
    v_cndmask_b32 v136, v136, v138, s[90:91]
    ds_read_b64_tr_b16 v[162:163], v233 offset:512
    v_mfma_f32_16x16x32_bf16 v[48:51], v[12:15], v[124:127], v[48:51]
    ds_read_b64_tr_b16 v[166:167], v234 offset:512
    ds_read_b64_tr_b16 v[138:139], v233 offset:768
    ds_read_b64_tr_b16 v[142:143], v234 offset:768
    v_cvt_pk_bf16_f32 v148, v36, v37
    v_cvt_pk_bf16_f32 v149, v38, v39
    v_mfma_f32_16x16x32_bf16 v[52:55], v[16:19], v[96:99], 0
    v_cvt_pk_bf16_f32 v156, v40, v41
    v_cvt_pk_bf16_f32 v157, v42, v43
    v_mov_b32 v254, v164
    s_waitcnt lgkmcnt(6)
    v_max_f32 v60, v60, v61
    v_mul_f32 v60, v60, v252
    v_mfma_f32_16x16x32_bf16 v[52:55], v[20:23], v[100:103], v[52:55]
    v_fma_f32 v56, v56, v252, -v60
    v_fma_f32 v57, v57, v252, -v60
    v_fma_f32 v58, v58, v252, -v60
    v_fma_f32 v59, v59, v252, -v60
    v_exp_f32 v56, v56
    v_mfma_f32_16x16x32_bf16 v[24:27], v[16:19], v[104:107], 0
    v_exp_f32 v57, v57
    v_exp_f32 v58, v58
    v_exp_f32 v59, v59
    v_mfma_f32_16x16x32_bf16 v[24:27], v[20:23], v[108:111], v[24:27]
    v_add_f32 v62, v56, v57
    v_add_f32 v63, v58, v59
    v_add_f32 v62, v62, v63
    ds_swizzle_b32 v63, v62 offset:0x401f
    v_mul_f32 v56, v56, v4
    v_mfma_f32_16x16x32_bf16 v[28:31], v[16:19], v[112:115], 0
    v_mul_f32 v57, v57, v5
    v_mul_f32 v58, v58, v6
    v_mul_f32 v59, v59, v7
    v_cvt_pk_bf16_f32 v168, v52, v53
    v_cvt_pk_bf16_f32 v169, v54, v55
    v_mfma_f32_16x16x32_bf16 v[28:31], v[20:23], v[116:119], v[28:31]
    v_cvt_pk_bf16_f32 v172, v24, v25
    v_cvt_pk_bf16_f32 v173, v26, v27
    v_mov_b32 v255, v165
    s_mov_b64 exec, s[92:93]
    ds_write_b32 v225, v160 offset:0
    s_mov_b64 exec, -1
    s_mov_b64 exec, s[92:93]
    ds_write_b32 v225, v136 offset:64
    s_mov_b64 exec, -1
    v_mfma_f32_16x16x32_bf16 v[32:35], v[16:19], v[120:123], 0
    v_cndmask_b32 v254, v254, v140, s[94:95]
    v_cndmask_b32 v255, v255, v141, s[94:95]
    v_cvt_pk_bf16_f32 v160, v44, v45
    v_cvt_pk_bf16_f32 v161, v46, v47
    v_cvt_pk_bf16_f32 v164, v48, v49
    v_mfma_f32_16x16x32_bf16 v[32:35], v[20:23], v[124:127], v[32:35]
    v_cvt_pk_bf16_f32 v165, v50, v51
    v_cvt_pk_bf16_f32 v136, v28, v29
    v_cvt_pk_bf16_f32 v137, v30, v31
    s_waitcnt lgkmcnt(2)
    v_add_f32 v62, v62, v63
    v_rcp_f32 v62, v62
    ds_read_b32 v252, v226
    v_mul_f32 v56, v56, v62
    v_mul_f32 v57, v57, v62
    v_mul_f32 v58, v58, v62
    v_mul_f32 v59, v59, v62
    v_cvt_pk_bf16_f32 v216, v56, v57
    v_cvt_pk_bf16_f32 v217, v58, v59
    v_cvt_pk_bf16_f32 v140, v32, v33
    v_and_b32_dpp v220, v216, v228 row_ror:8 row_mask:0xf bank_mask:0xf
    v_and_b32_dpp v221, v217, v228 row_ror:8 row_mask:0xf bank_mask:0xf
    v_and_b32 v216, v216, v228
    v_and_b32 v217, v217, v228
    v_mfma_f32_16x16x32_bf16 v[52:55], v[168:171], v[220:223], 0
    v_cvt_pk_bf16_f32 v141, v34, v35
    ds_read_b128 v[4:7], v242 offset:0
    v_mfma_f32_16x16x32_bf16 v[36:39], v[148:151], v[216:219], 0
    v_add_u32 v226, s75, v226
    v_mfma_f32_16x16x32_bf16 v[24:27], v[172:175], v[220:223], 0
    v_mfma_f32_16x16x32_bf16 v[40:43], v[156:159], v[216:219], 0
    s_waitcnt lgkmcnt(1)
    v_lshlrev_b32 v252, 16, v252
    v_mfma_f32_16x16x32_bf16 v[28:31], v[136:139], v[220:223], 0
    v_cvt_pk_bf16_f32 v168, v52, v53
    v_cvt_pk_bf16_f32 v169, v54, v55
    v_mfma_f32_16x16x32_bf16 v[44:47], v[160:163], v[216:219], 0
    v_cvt_pk_bf16_f32 v148, v36, v37
    v_cvt_pk_bf16_f32 v149, v38, v39
    v_mfma_f32_16x16x32_bf16 v[48:51], v[164:167], v[216:219], 0
    v_cvt_pk_bf16_f32 v150, v40, v41
    v_cvt_pk_bf16_f32 v151, v42, v43
    v_mfma_f32_16x16x32_bf16 v[32:35], v[140:143], v[220:223], 0
    v_cvt_pk_bf16_f32 v170, v24, v25
    v_cvt_pk_bf16_f32 v171, v26, v27
    v_mfma_f32_16x16x32_bf16 v[160:163], v[148:151], v[148:151], 0
    v_cvt_pk_bf16_f32 v156, v44, v45
    v_cvt_pk_bf16_f32 v157, v46, v47
    v_mfma_f32_16x16x32_bf16 v[136:139], v[168:171], v[168:171], 0
    v_cvt_pk_bf16_f32 v158, v48, v49
    v_cvt_pk_bf16_f32 v159, v50, v51
    v_mfma_f32_16x16x32_bf16 v[164:167], v[208:211], v[148:151], 0
    v_cvt_pk_bf16_f32 v172, v28, v29
    v_cvt_pk_bf16_f32 v173, v30, v31
    v_mfma_f32_16x16x32_bf16 v[160:163], v[156:159], v[156:159], v[160:163]
    v_cvt_pk_bf16_f32 v174, v32, v33
    v_cvt_pk_bf16_f32 v175, v34, v35
    v_mfma_f32_16x16x32_bf16 v[140:143], v[208:211], v[168:171], 0
    ds_write_b64 v235, v[148:149] offset:512
    v_mfma_f32_16x16x32_bf16 v[136:139], v[172:175], v[172:175], v[136:139]
    ds_write_b64 v236, v[150:151] offset:512
    v_mfma_f32_16x16x32_bf16 v[164:167], v[212:215], v[156:159], v[164:167]
    ds_write_b64 v237, v[156:157] offset:512
    v_mfma_f32_16x16x32_bf16 v[140:143], v[212:215], v[172:175], v[140:143]
    v_cndmask_b32 v160, v160, v161, s[88:89]
    v_cndmask_b32 v162, v162, v163, s[88:89]
    v_cndmask_b32 v160, v160, v162, s[90:91]
    s_mov_b64 exec, s[92:93]
    ds_write_b32 v225, v160 offset:128
    s_mov_b64 exec, -1
    v_cndmask_b32 v136, v136, v137, s[88:89]
    v_cndmask_b32 v138, v138, v139, s[88:89]
    v_cndmask_b32 v136, v136, v138, s[90:91]
    s_mov_b64 exec, s[92:93]
    ds_write_b32 v225, v136 offset:192
    s_mov_b64 exec, -1
    ds_read_b32 v224, v227
    v_cndmask_b32 v254, v254, v164, s[28:29]
    ds_write_b64 v238, v[158:159] offset:512
    ds_write_b64 v235, v[168:169] offset:768
    ds_write_b64 v236, v[170:171] offset:768
    ds_write_b64 v237, v[172:173] offset:768
    ds_write_b64 v238, v[174:175] offset:768
    v_cndmask_b32 v254, v254, v140, s[30:31]
    v_xor_b32 v227, 32, v239
    v_mul_f32 v254, v254, v254
    ds_read_b64_tr_b16 v[156:157], v227 offset:0
    ds_read_b64_tr_b16 v[172:173], v227 offset:512
    v_xor_b32 v227, 32, v240
    ds_read_b64_tr_b16 v[158:159], v227 offset:0
    ds_read_b64_tr_b16 v[174:175], v227 offset:512
    v_xor_b32 v227, 64, v239
    v_cndmask_b32 v255, v255, v165, s[28:29]
    ds_read_b64_tr_b16 v[160:161], v227 offset:0
    ds_read_b64_tr_b16 v[136:137], v227 offset:512
    v_cndmask_b32 v255, v255, v141, s[30:31]
    v_xor_b32 v227, 64, v240
    ds_read_b64_tr_b16 v[162:163], v227 offset:0
    ds_read_b64_tr_b16 v[138:139], v227 offset:512
    s_waitcnt lgkmcnt(13)
    v_fma_f32 v254, v224, s74, -v254
    v_max_f32 v254, 0, v254
    v_add_f32 v254, 0x3d27c5ac, v254
    v_rsq_f32 v254, v254
    v_xor_b32 v227, 96, v239
    v_mul_f32 v254, v254, v255
    ds_read_b64_tr_b16 v[164:165], v227 offset:0
    ds_read_b64_tr_b16 v[140:141], v227 offset:512
    v_max_f32_dpp v224, v254, v254 quad_perm:[1,0,3,2] row_mask:0xf bank_mask:0xf
    v_xor_b32 v227, 96, v240
    ds_read_b64_tr_b16 v[166:167], v227 offset:0
    v_max_f32_dpp v224, v224, v224 quad_perm:[2,3,0,1] row_mask:0xf bank_mask:0xf
    ds_read_b64_tr_b16 v[142:143], v227 offset:512
    v_mov_b32 v227, s6
    v_max_f32_dpp v224, v224, v224 row_half_mirror row_mask:0xf bank_mask:0xf
    v_cndmask_b32 v227, 0, v227, s[32:33]
    v_sub_f32 v254, v254, v224
    v_add_u32 v229, v227, v229
    v_add_u32 v230, v227, v230
    v_add_u32 v235, v227, v235
    v_add_u32 v236, v227, v236
    v_add_u32 v237, v227, v237
    v_add_u32 v238, v227, v238
    v_exp_f32 v254, v254
    v_mov_b32 v227, s6
    v_cndmask_b32 v227, 0, v227, s[34:35]
    v_add_u32 v231, v227, v231
    v_add_u32 v232, v227, v232
    v_add_u32 v233, v227, v233
    v_add_u32 v234, v227, v234
    v_add_f32_dpp v224, v254, v254 quad_perm:[1,0,3,2] row_mask:0xf bank_mask:0xf
    v_mov_b32 v227, s6
    ds_read_b64_tr_b16 v[148:149], v239 offset:0
    ds_read_b64_tr_b16 v[168:169], v239 offset:512
    v_cndmask_b32 v227, 0, v227, s[60:61]
    v_add_f32_dpp v224, v224, v224 quad_perm:[2,3,0,1] row_mask:0xf bank_mask:0xf
    v_add_u32 v239, v227, v239
    ds_read_b64_tr_b16 v[150:151], v240 offset:0
    ds_read_b64_tr_b16 v[170:171], v240 offset:512
    v_xor_b32 v227, 160, v247
    v_add_f32_dpp v224, v224, v224 row_half_mirror row_mask:0xf bank_mask:0xf
    s_setprio 0
    ds_write_b128 v227, v[192:195] offset:0
    v_rcp_f32 v224, v224
    v_xor_b32 v227, 64, v247
    v_mul_f32 v254, v254, v224
    v_cvt_pk_bf16_f32 v254, v254, v254
    ds_write_b128 v227, v[196:199] offset:1024
    ds_write_b16 v243, v254
    v_and_b32 v254, 0xffff0000, v254
    v_xor_b32 v227, 192, v247
    v_mul_f32 v254, v254, v252
    ds_write_b128 v227, v[200:203] offset:2048
    v_xor_b32 v227, 96, v247
    v_add_f32_dpp v254, v254, v254 quad_perm:[1,0,3,2] row_mask:0xf bank_mask:0xf
    ds_write_b128 v227, v[204:207] offset:3072
    v_lshlrev_b32 v224, 3, v225
    v_add_f32_dpp v254, v254, v254 quad_perm:[2,3,0,1] row_mask:0xf bank_mask:0xf
    v_xor_b32 v227, 224, v247
    ds_write_b128 v227, v[152:155] offset:4096
    v_add_f32_dpp v254, v254, v254 row_half_mirror row_mask:0xf bank_mask:0xf
    ds_bpermute_b32 v36, v224, v254
    ds_read_b128 v[40:43], v244
    ds_read_b128 v[8:11], v229 offset:0
    ds_read_b128 v[16:19], v229 offset:256
    ds_read_b128 v[44:47], v245
    ds_read_b128 v[12:15], v230 offset:0
    ds_read_b128 v[20:23], v230 offset:256
    ds_read_b32 v252, v241 offset:0
    ds_read_b32 v255, v246
    v_lshl_add_u32 v227, v243, 1, s72
    v_add_u32 v240, s68, v240
    v_add_u32 v246, s40, v246
    s_waitcnt lgkmcnt(8)
    v_mov_b32 v37, v36
    v_mov_b32 v38, v36
    v_mov_b32 v39, v36
    s_waitcnt lgkmcnt(6)
    v_mfma_f32_16x16x32_bf16 v[48:51], v[64:67], v[8:11], 0
    v_mfma_f32_16x16x32_bf16 v[248:251], v[148:151], v[40:43], v[36:39]
    v_mfma_f32_16x16x32_bf16 v[0:3], v[156:159], v[40:43], v[36:39]
    ds_read_b64_tr_b16 v[158:159], v232 offset:0
    s_waitcnt lgkmcnt(1)
    v_or_b32 v255, v255, v253
    v_mfma_f32_16x16x32_bf16 v[56:59], v[160:163], v[40:43], v[36:39]
    ds_read_b64_tr_b16 v[162:163], v233 offset:0
    v_mfma_f32_16x16x32_bf16 v[60:63], v[164:167], v[40:43], v[36:39]
    ds_read_b64_tr_b16 v[166:167], v234 offset:0
    v_mfma_f32_16x16x32_bf16 v[52:55], v[72:75], v[8:11], 0
    v_mfma_f32_16x16x32_bf16 v[32:35], v[64:67], v[16:19], 0
    v_mfma_f32_16x16x32_bf16 v[36:39], v[72:75], v[16:19], 0
    v_mfma_f32_16x16x32_bf16 v[248:251], v[168:171], v[44:47], v[248:251]
    ds_read_b64_tr_b16 v[170:171], v231 offset:256
    v_mfma_f32_16x16x32_bf16 v[0:3], v[172:175], v[44:47], v[0:3]
    ds_read_b64_tr_b16 v[174:175], v232 offset:256
    v_mfma_f32_16x16x32_bf16 v[56:59], v[136:139], v[44:47], v[56:59]
    ds_read_b64_tr_b16 v[138:139], v233 offset:256
    v_mfma_f32_16x16x32_bf16 v[60:63], v[140:143], v[44:47], v[60:63]
    ds_read_b64_tr_b16 v[142:143], v234 offset:256
    v_mfma_f32_16x16x32_bf16 v[24:27], v[80:83], v[8:11], 0
    v_mfma_f32_16x16x32_bf16 v[28:31], v[88:91], v[8:11], 0
    v_mfma_f32_16x16x32_bf16 v[48:51], v[68:71], v[12:15], v[48:51]
    v_mfma_f32_16x16x32_bf16 v[40:43], v[80:83], v[16:19], 0
    s_nop 0
    v_cndmask_b32 v248, v248, v56, s[78:79]
    v_mfma_f32_16x16x32_bf16 v[52:55], v[76:79], v[12:15], v[52:55]
    v_cndmask_b32 v249, v249, v57, s[78:79]
    v_cndmask_b32 v250, v250, v58, s[78:79]
    v_mfma_f32_16x16x32_bf16 v[32:35], v[68:71], v[20:23], v[32:35]
    v_cndmask_b32 v251, v251, v59, s[78:79]
    v_cndmask_b32 v0, v0, v60, s[78:79]
    v_mfma_f32_16x16x32_bf16 v[36:39], v[76:79], v[20:23], v[36:39]
    v_cndmask_b32 v1, v1, v61, s[78:79]
    v_cndmask_b32 v2, v2, v62, s[78:79]
    v_mfma_f32_16x16x32_bf16 v[44:47], v[88:91], v[16:19], 0
    v_cndmask_b32 v3, v3, v63, s[78:79]
    v_cvt_pk_bf16_f32 v56, v48, v49
    v_mfma_f32_16x16x32_bf16 v[24:27], v[84:87], v[12:15], v[24:27]
    v_cvt_pk_bf16_f32 v57, v50, v51
    v_cvt_pk_bf16_f32 v58, v52, v53
    v_mfma_f32_16x16x32_bf16 v[28:31], v[92:95], v[12:15], v[28:31]
    v_cvt_pk_bf16_f32 v59, v54, v55
    v_cvt_pk_bf16_f32 v128, v32, v33
    v_mfma_f32_16x16x32_bf16 v[40:43], v[84:87], v[20:23], v[40:43]
    v_cvt_pk_bf16_f32 v129, v34, v35
    v_cvt_pk_bf16_f32 v130, v36, v37
    v_mfma_f32_16x16x32_bf16 v[44:47], v[92:95], v[20:23], v[44:47]
    v_cvt_pk_bf16_f32 v131, v38, v39
    v_cvt_pk_bf16_f32 v148, v248, v249
    v_cvt_pk_bf16_f32 v149, v250, v251
    v_mfma_f32_16x16x32_bf16 v[248:251], v[8:11], v[56:59], 0
    v_cvt_pk_bf16_f32 v150, v0, v1
    v_cvt_pk_bf16_f32 v151, v2, v3
    v_mfma_f32_16x16x32_bf16 v[0:3], v[16:19], v[128:131], 0
    v_cvt_pk_bf16_f32 v60, v24, v25
    v_cvt_pk_bf16_f32 v61, v26, v27
    v_cvt_pk_bf16_f32 v62, v28, v29
    v_cvt_pk_bf16_f32 v63, v30, v31
    v_cvt_pk_bf16_f32 v132, v40, v41
    v_cvt_pk_bf16_f32 v133, v42, v43
    v_mfma_f32_16x16x32_bf16 v[248:251], v[12:15], v[60:63], v[248:251]
    v_cvt_pk_bf16_f32 v134, v44, v45
    v_cvt_pk_bf16_f32 v135, v46, v47
    v_permlane16_swap_b32 v148, v150
    v_permlane16_swap_b32 v149, v151
    v_mfma_f32_16x16x32_bf16 v[0:3], v[20:23], v[132:135], v[0:3]
    buffer_store_dwordx4 v[148:151], v255, s[20:23], 0 offen sc1
    v_mfma_f32_16x16x32_bf16 v[48:51], v[8:11], v[96:99], 0
    ds_read_b64_tr_b16 v[150:151], v231 offset:0
    v_mfma_f32_16x16x32_bf16 v[48:51], v[12:15], v[100:103], v[48:51]
    s_nop 3
    v_cndmask_b32_dpp v56, v0, v248, vcc row_ror:8 row_mask:0xf bank_mask:0xf
    v_mfma_f32_16x16x32_bf16 v[52:55], v[8:11], v[104:107], 0
    v_mul_f32 v56, v56, v4
    v_cndmask_b32_dpp v57, v1, v249, vcc row_ror:8 row_mask:0xf bank_mask:0xf
    v_cndmask_b32_dpp v58, v2, v250, vcc row_ror:8 row_mask:0xf bank_mask:0xf
    v_cndmask_b32_dpp v59, v3, v251, vcc row_ror:8 row_mask:0xf bank_mask:0xf
    v_mfma_f32_16x16x32_bf16 v[52:55], v[12:15], v[108:111], v[52:55]
    v_mul_f32 v57, v57, v5
    v_mul_f32 v58, v58, v6
    v_mul_f32 v59, v59, v7
    v_max3_f32 v60, v56, v57, v58
    v_max_f32 v60, v60, v59
    v_mfma_f32_16x16x32_bf16 v[24:27], v[8:11], v[112:115], 0
    ds_swizzle_b32 v61, v60 offset:0x401f
    v_cvt_pk_bf16_f32 v148, v48, v49
    v_cvt_pk_bf16_f32 v149, v50, v51
    v_cvt_pk_bf16_f32 v156, v52, v53
    v_cvt_pk_bf16_f32 v157, v54, v55
    v_mfma_f32_16x16x32_bf16 v[24:27], v[12:15], v[116:119], v[24:27]
    v_mfma_f32_16x16x32_bf16 v[28:31], v[8:11], v[120:123], 0
    ds_read_b128 v[8:11], v229 offset:512
    v_mfma_f32_16x16x32_bf16 v[28:31], v[12:15], v[124:127], v[28:31]
    ds_read_b128 v[12:15], v230 offset:512
    v_mfma_f32_16x16x32_bf16 v[32:35], v[16:19], v[96:99], 0
    s_waitcnt lgkmcnt(2)
    v_max_f32 v60, v60, v61
    v_mul_f32 v60, v60, v252
    v_fma_f32 v56, v56, v252, -v60
    v_fma_f32 v57, v57, v252, -v60
    v_fma_f32 v58, v58, v252, -v60
    v_mfma_f32_16x16x32_bf16 v[32:35], v[20:23], v[100:103], v[32:35]
    v_fma_f32 v59, v59, v252, -v60
    v_exp_f32 v56, v56
    v_exp_f32 v57, v57
    v_mfma_f32_16x16x32_bf16 v[36:39], v[16:19], v[104:107], 0
    v_exp_f32 v58, v58
    v_exp_f32 v59, v59
    v_add_f32 v62, v56, v57
    v_mfma_f32_16x16x32_bf16 v[36:39], v[20:23], v[108:111], v[36:39]
    v_add_f32 v63, v58, v59
    v_add_f32 v62, v62, v63
    ds_swizzle_b32 v63, v62 offset:0x401f
    v_mul_f32 v56, v56, v4
    v_mul_f32 v57, v57, v5
    v_mfma_f32_16x16x32_bf16 v[40:43], v[16:19], v[112:115], 0
    v_mul_f32 v58, v58, v6
    v_mul_f32 v59, v59, v7
    v_cvt_pk_bf16_f32 v168, v32, v33
    v_cvt_pk_bf16_f32 v169, v34, v35
    v_cvt_pk_bf16_f32 v172, v36, v37
    v_mfma_f32_16x16x32_bf16 v[40:43], v[20:23], v[116:119], v[40:43]
    v_cvt_pk_bf16_f32 v173, v38, v39
    v_cvt_pk_bf16_f32 v160, v24, v25
    v_cvt_pk_bf16_f32 v161, v26, v27
    v_cvt_pk_bf16_f32 v164, v28, v29
    v_cvt_pk_bf16_f32 v165, v30, v31
    v_mfma_f32_16x16x32_bf16 v[44:47], v[16:19], v[120:123], 0
    ds_read_b128 v[16:19], v229 offset:768
    ds_read_b128 v[4:7], v242 offset:128
    v_cvt_pk_bf16_f32 v136, v40, v41
    v_mfma_f32_16x16x32_bf16 v[44:47], v[20:23], v[124:127], v[44:47]
    ds_read_b128 v[20:23], v230 offset:768
    s_waitcnt lgkmcnt(3)
    v_add_f32 v62, v62, v63
    v_rcp_f32 v62, v62
    v_cvt_pk_bf16_f32 v137, v42, v43
    v_mul_f32 v56, v56, v62
    v_mul_f32 v57, v57, v62
    v_mul_f32 v58, v58, v62
    v_mul_f32 v59, v59, v62
    v_cvt_pk_bf16_f32 v216, v56, v57
    v_cvt_pk_bf16_f32 v217, v58, v59
    v_cvt_pk_bf16_f32 v140, v44, v45
    v_and_b32_dpp v220, v216, v228 row_ror:8 row_mask:0xf bank_mask:0xf
    v_and_b32_dpp v221, v217, v228 row_ror:8 row_mask:0xf bank_mask:0xf
    v_and_b32 v216, v216, v228
    v_and_b32 v217, v217, v228
    v_mfma_f32_16x16x32_bf16 v[32:35], v[168:171], v[220:223], 0
    v_cvt_pk_bf16_f32 v141, v46, v47
    ds_read_b32 v252, v241 offset:128
    v_mfma_f32_16x16x32_bf16 v[48:51], v[148:151], v[216:219], 0
    v_mfma_f32_16x16x32_bf16 v[36:39], v[172:175], v[220:223], 0
    v_mfma_f32_16x16x32_bf16 v[52:55], v[156:159], v[216:219], 0
    v_mfma_f32_16x16x32_bf16 v[40:43], v[136:139], v[220:223], 0
    v_mfma_f32_16x16x32_bf16 v[24:27], v[160:163], v[216:219], 0
    s_nop 0
    v_cvt_pk_bf16_f32 v168, v32, v33
    v_mfma_f32_16x16x32_bf16 v[28:31], v[164:167], v[216:219], 0
    v_cvt_pk_bf16_f32 v169, v34, v35
    ds_write_b64 v235, v[168:169] offset:256
    v_mfma_f32_16x16x32_bf16 v[44:47], v[140:143], v[220:223], 0
    v_cvt_pk_bf16_f32 v148, v48, v49
    v_cvt_pk_bf16_f32 v149, v50, v51
    v_mfma_f32_16x16x32_bf16 v[48:51], v[64:67], v[8:11], 0
    v_cvt_pk_bf16_f32 v150, v52, v53
    v_cvt_pk_bf16_f32 v151, v54, v55
    v_mfma_f32_16x16x32_bf16 v[52:55], v[72:75], v[8:11], 0
    v_cvt_pk_bf16_f32 v170, v36, v37
    v_cvt_pk_bf16_f32 v171, v38, v39
    s_waitcnt lgkmcnt(4)
    v_mfma_f32_16x16x32_bf16 v[32:35], v[64:67], v[16:19], 0
    v_cvt_pk_bf16_f32 v156, v24, v25
    v_cvt_pk_bf16_f32 v157, v26, v27
    v_mfma_f32_16x16x32_bf16 v[36:39], v[72:75], v[16:19], 0
    v_cvt_pk_bf16_f32 v158, v28, v29
    v_cvt_pk_bf16_f32 v159, v30, v31
    v_mfma_f32_16x16x32_bf16 v[48:51], v[68:71], v[12:15], v[48:51]
    v_cvt_pk_bf16_f32 v172, v40, v41
    v_cvt_pk_bf16_f32 v173, v42, v43
    v_mfma_f32_16x16x32_bf16 v[52:55], v[76:79], v[12:15], v[52:55]
    v_cvt_pk_bf16_f32 v174, v44, v45
    v_cvt_pk_bf16_f32 v175, v46, v47
    v_mfma_f32_16x16x32_bf16 v[24:27], v[80:83], v[8:11], 0
    ds_write_b64 v236, v[150:151] offset:0
    v_mfma_f32_16x16x32_bf16 v[28:31], v[88:91], v[8:11], 0
    v_cvt_pk_bf16_f32 v56, v48, v49
    v_cvt_pk_bf16_f32 v57, v50, v51
    s_waitcnt lgkmcnt(3)
    v_mfma_f32_16x16x32_bf16 v[32:35], v[68:71], v[20:23], v[32:35]
    v_cvt_pk_bf16_f32 v58, v52, v53
    v_cvt_pk_bf16_f32 v59, v54, v55
    v_mfma_f32_16x16x32_bf16 v[36:39], v[76:79], v[20:23], v[36:39]
    ds_write_b64 v236, v[170:171] offset:256
    v_mfma_f32_16x16x32_bf16 v[40:43], v[80:83], v[16:19], 0
    ds_write_b64 v238, v[158:159] offset:0
    v_mfma_f32_16x16x32_bf16 v[44:47], v[88:91], v[16:19], 0
    ds_write_b64 v238, v[174:175] offset:256
    v_mfma_f32_16x16x32_bf16 v[24:27], v[84:87], v[12:15], v[24:27]
    v_cvt_pk_bf16_f32 v128, v32, v33
    v_cvt_pk_bf16_f32 v129, v34, v35
    v_mfma_f32_16x16x32_bf16 v[28:31], v[92:95], v[12:15], v[28:31]
    v_cvt_pk_bf16_f32 v130, v36, v37
    v_cvt_pk_bf16_f32 v131, v38, v39
    v_mfma_f32_16x16x32_bf16 v[40:43], v[84:87], v[20:23], v[40:43]
    ds_write_b64 v235, v[148:149] offset:0
    v_mfma_f32_16x16x32_bf16 v[44:47], v[92:95], v[20:23], v[44:47]
    v_cvt_pk_bf16_f32 v60, v24, v25
    v_cvt_pk_bf16_f32 v61, v26, v27
    v_mfma_f32_16x16x32_bf16 v[248:251], v[8:11], v[56:59], 0
    v_cvt_pk_bf16_f32 v62, v28, v29
    v_cvt_pk_bf16_f32 v63, v30, v31
    v_mfma_f32_16x16x32_bf16 v[0:3], v[16:19], v[128:131], 0
    v_cvt_pk_bf16_f32 v132, v40, v41
    v_cvt_pk_bf16_f32 v133, v42, v43
    v_mfma_f32_16x16x32_bf16 v[248:251], v[12:15], v[60:63], v[248:251]
    v_cvt_pk_bf16_f32 v134, v44, v45
    v_cvt_pk_bf16_f32 v135, v46, v47
    v_mfma_f32_16x16x32_bf16 v[160:163], v[148:151], v[148:151], 0
    ds_write_b64 v237, v[156:157] offset:0
    v_mfma_f32_16x16x32_bf16 v[0:3], v[20:23], v[132:135], v[0:3]
    ds_write_b64 v237, v[172:173] offset:256
    v_mfma_f32_16x16x32_bf16 v[48:51], v[8:11], v[96:99], 0
    v_mfma_f32_16x16x32_bf16 v[136:139], v[168:171], v[168:171], 0
    v_mfma_f32_16x16x32_bf16 v[48:51], v[12:15], v[100:103], v[48:51]
    v_mfma_f32_16x16x32_bf16 v[164:167], v[208:211], v[148:151], 0
    ds_read_b64_tr_b16 v[150:151], v231 offset:512
    v_mfma_f32_16x16x32_bf16 v[52:55], v[8:11], v[104:107], 0
    s_nop 0
    v_cndmask_b32_dpp v56, v0, v248, vcc row_ror:8 row_mask:0xf bank_mask:0xf
    v_mfma_f32_16x16x32_bf16 v[140:143], v[208:211], v[168:171], 0
    v_cndmask_b32_dpp v57, v1, v249, vcc row_ror:8 row_mask:0xf bank_mask:0xf
    v_cndmask_b32_dpp v58, v2, v250, vcc row_ror:8 row_mask:0xf bank_mask:0xf
    v_mfma_f32_16x16x32_bf16 v[52:55], v[12:15], v[108:111], v[52:55]
    v_cndmask_b32_dpp v59, v3, v251, vcc row_ror:8 row_mask:0xf bank_mask:0xf
    v_mul_f32 v56, v56, v4
    v_mfma_f32_16x16x32_bf16 v[160:163], v[156:159], v[156:159], v[160:163]
    v_mul_f32 v57, v57, v5
    v_mul_f32 v58, v58, v6
    v_mfma_f32_16x16x32_bf16 v[24:27], v[8:11], v[112:115], 0
    v_mul_f32 v59, v59, v7
    v_max3_f32 v60, v56, v57, v58
    v_mfma_f32_16x16x32_bf16 v[136:139], v[172:175], v[172:175], v[136:139]
    v_max_f32 v60, v60, v59
    ds_swizzle_b32 v61, v60 offset:0x401f
    v_mfma_f32_16x16x32_bf16 v[24:27], v[12:15], v[116:119], v[24:27]
    ds_read_b64_tr_b16 v[170:171], v231 offset:768
    v_cndmask_b32 v160, v160, v161, s[88:89]
    v_mfma_f32_16x16x32_bf16 v[164:167], v[212:215], v[156:159], v[164:167]
    ds_read_b64_tr_b16 v[158:159], v232 offset:512
    v_cndmask_b32 v162, v162, v163, s[88:89]
    v_mfma_f32_16x16x32_bf16 v[28:31], v[8:11], v[120:123], 0
    v_cndmask_b32 v136, v136, v137, s[88:89]
    v_cndmask_b32 v138, v138, v139, s[88:89]
    v_mfma_f32_16x16x32_bf16 v[140:143], v[212:215], v[172:175], v[140:143]
    ds_read_b64_tr_b16 v[174:175], v232 offset:768
    v_cndmask_b32 v160, v160, v162, s[90:91]
    v_mfma_f32_16x16x32_bf16 v[28:31], v[12:15], v[124:127], v[28:31]
    v_cndmask_b32 v136, v136, v138, s[90:91]
    ds_read_b64_tr_b16 v[162:163], v233 offset:512
    ds_read_b64_tr_b16 v[166:167], v234 offset:512
    ds_read_b64_tr_b16 v[138:139], v233 offset:768
    v_cvt_pk_bf16_f32 v148, v48, v49
    v_mfma_f32_16x16x32_bf16 v[32:35], v[16:19], v[96:99], 0
    ds_read_b64_tr_b16 v[142:143], v234 offset:768
    v_cvt_pk_bf16_f32 v149, v50, v51
    s_waitcnt lgkmcnt(7)
    v_max_f32 v60, v60, v61
    v_mul_f32 v60, v60, v252
    v_fma_f32 v56, v56, v252, -v60
    v_mfma_f32_16x16x32_bf16 v[32:35], v[20:23], v[100:103], v[32:35]
    v_fma_f32 v57, v57, v252, -v60
    v_fma_f32 v58, v58, v252, -v60
    v_fma_f32 v59, v59, v252, -v60
    v_exp_f32 v56, v56
    v_mfma_f32_16x16x32_bf16 v[36:39], v[16:19], v[104:107], 0
    v_exp_f32 v57, v57
    v_exp_f32 v58, v58
    v_exp_f32 v59, v59
    v_mfma_f32_16x16x32_bf16 v[36:39], v[20:23], v[108:111], v[36:39]
    v_add_f32 v62, v56, v57
    v_add_f32 v63, v58, v59
    v_add_f32 v62, v62, v63
    ds_swizzle_b32 v63, v62 offset:0x401f
    v_mul_f32 v56, v56, v4
    v_mfma_f32_16x16x32_bf16 v[40:43], v[16:19], v[112:115], 0
    v_mul_f32 v57, v57, v5
    v_mul_f32 v58, v58, v6
    v_mul_f32 v59, v59, v7
    v_cvt_pk_bf16_f32 v168, v32, v33
    v_cvt_pk_bf16_f32 v169, v34, v35
    v_mfma_f32_16x16x32_bf16 v[40:43], v[20:23], v[116:119], v[40:43]
    v_cvt_pk_bf16_f32 v156, v52, v53
    v_cvt_pk_bf16_f32 v157, v54, v55
    v_cvt_pk_bf16_f32 v172, v36, v37
    v_cvt_pk_bf16_f32 v173, v38, v39
    v_mov_b32 v254, v164
    v_mfma_f32_16x16x32_bf16 v[44:47], v[16:19], v[120:123], 0
    v_mov_b32 v255, v165
    s_mov_b64 exec, s[92:93]
    ds_write_b32 v225, v160 offset:0
    s_mov_b64 exec, -1
    s_mov_b64 exec, s[92:93]
    ds_write_b32 v225, v136 offset:64
    s_mov_b64 exec, -1
    v_cndmask_b32 v254, v254, v140, s[94:95]
    v_cndmask_b32 v255, v255, v141, s[94:95]
    v_mfma_f32_16x16x32_bf16 v[44:47], v[20:23], v[124:127], v[44:47]
    v_cvt_pk_bf16_f32 v160, v24, v25
    v_cvt_pk_bf16_f32 v161, v26, v27
    v_cvt_pk_bf16_f32 v164, v28, v29
    s_waitcnt lgkmcnt(2)
    v_add_f32 v62, v62, v63
    v_rcp_f32 v62, v62
    v_cvt_pk_bf16_f32 v165, v30, v31
    v_mul_f32 v56, v56, v62
    v_mul_f32 v57, v57, v62
    v_mul_f32 v58, v58, v62
    v_mul_f32 v59, v59, v62
    v_cvt_pk_bf16_f32 v216, v56, v57
    v_cvt_pk_bf16_f32 v217, v58, v59
    v_cvt_pk_bf16_f32 v136, v40, v41
    v_and_b32_dpp v220, v216, v228 row_ror:8 row_mask:0xf bank_mask:0xf
    v_and_b32_dpp v221, v217, v228 row_ror:8 row_mask:0xf bank_mask:0xf
    v_and_b32 v216, v216, v228
    v_and_b32 v217, v217, v228
    v_mfma_f32_16x16x32_bf16 v[32:35], v[168:171], v[220:223], 0
    v_cvt_pk_bf16_f32 v137, v42, v43
    v_cvt_pk_bf16_f32 v140, v44, v45
    v_mfma_f32_16x16x32_bf16 v[48:51], v[148:151], v[216:219], 0
    v_cvt_pk_bf16_f32 v141, v46, v47
    ds_read_b32 v252, v226
    v_mfma_f32_16x16x32_bf16 v[52:55], v[156:159], v[216:219], 0
    v_mfma_f32_16x16x32_bf16 v[36:39], v[172:175], v[220:223], 0
    s_nop 0
    v_cvt_pk_bf16_f32 v168, v32, v33
    v_mfma_f32_16x16x32_bf16 v[24:27], v[160:163], v[216:219], 0
    v_cvt_pk_bf16_f32 v169, v34, v35
    ds_write_b64 v235, v[168:169] offset:768
    v_mfma_f32_16x16x32_bf16 v[28:31], v[164:167], v[216:219], 0
    v_cvt_pk_bf16_f32 v148, v48, v49
    v_cvt_pk_bf16_f32 v149, v50, v51
    v_mfma_f32_16x16x32_bf16 v[40:43], v[136:139], v[220:223], 0
    v_cvt_pk_bf16_f32 v150, v52, v53
    v_cvt_pk_bf16_f32 v151, v54, v55
    v_mfma_f32_16x16x32_bf16 v[44:47], v[140:143], v[220:223], 0
    v_cvt_pk_bf16_f32 v170, v36, v37
    v_cvt_pk_bf16_f32 v171, v38, v39
    v_mfma_f32_16x16x32_bf16 v[160:163], v[148:151], v[148:151], 0
    v_cvt_pk_bf16_f32 v156, v24, v25
    v_cvt_pk_bf16_f32 v157, v26, v27
    v_mfma_f32_16x16x32_bf16 v[136:139], v[168:171], v[168:171], 0
    v_cvt_pk_bf16_f32 v158, v28, v29
    v_cvt_pk_bf16_f32 v159, v30, v31
    v_mfma_f32_16x16x32_bf16 v[164:167], v[208:211], v[148:151], 0
    v_cvt_pk_bf16_f32 v172, v40, v41
    v_cvt_pk_bf16_f32 v173, v42, v43
    v_mfma_f32_16x16x32_bf16 v[160:163], v[156:159], v[156:159], v[160:163]
    v_cvt_pk_bf16_f32 v174, v44, v45
    v_cvt_pk_bf16_f32 v175, v46, v47
    v_mfma_f32_16x16x32_bf16 v[140:143], v[208:211], v[168:171], 0
    ds_write_b64 v235, v[148:149] offset:512
    v_mfma_f32_16x16x32_bf16 v[136:139], v[172:175], v[172:175], v[136:139]
    ds_write_b64 v236, v[150:151] offset:512
    v_mfma_f32_16x16x32_bf16 v[164:167], v[212:215], v[156:159], v[164:167]
    ds_write_b64 v237, v[156:157] offset:512
    v_mfma_f32_16x16x32_bf16 v[140:143], v[212:215], v[172:175], v[140:143]
    v_cndmask_b32 v160, v160, v161, s[88:89]
    v_cndmask_b32 v162, v162, v163, s[88:89]
    v_cndmask_b32 v160, v160, v162, s[90:91]
    s_mov_b64 exec, s[92:93]
    ds_write_b32 v225, v160 offset:128
    s_mov_b64 exec, -1
    v_cndmask_b32 v136, v136, v137, s[88:89]
    v_cndmask_b32 v138, v138, v139, s[88:89]
    v_cndmask_b32 v136, v136, v138, s[90:91]
    s_mov_b64 exec, s[92:93]
    ds_write_b32 v225, v136 offset:192
    s_mov_b64 exec, -1
    ds_read_b32 v224, v227
    v_cndmask_b32 v254, v254, v164, s[28:29]
    v_cndmask_b32 v254, v254, v140, s[30:31]
    v_mul_f32 v254, v254, v254
    v_cndmask_b32 v255, v255, v165, s[28:29]
    v_cndmask_b32 v255, v255, v141, s[30:31]
    ds_write_b64 v238, v[158:159] offset:512
    ds_write_b64 v236, v[170:171] offset:768
    ds_write_b64 v237, v[172:173] offset:768
    ds_write_b64 v238, v[174:175] offset:768
    v_xor_b32 v227, 32, v239
    s_waitcnt lgkmcnt(11)
    v_lshlrev_b32 v252, 16, v252
    ds_read_b64_tr_b16 v[156:157], v227 offset:0
    ds_read_b64_tr_b16 v[172:173], v227 offset:512
    v_xor_b32 v227, 32, v240
    ds_read_b64_tr_b16 v[158:159], v227 offset:0
    ds_read_b64_tr_b16 v[174:175], v227 offset:512
    v_xor_b32 v227, 64, v239
    ds_read_b64_tr_b16 v[160:161], v227 offset:0
    ds_read_b64_tr_b16 v[136:137], v227 offset:512
    v_xor_b32 v227, 64, v240
    ds_read_b64_tr_b16 v[162:163], v227 offset:0
    ds_read_b64_tr_b16 v[138:139], v227 offset:512
    v_xor_b32 v227, 96, v239
    s_waitcnt lgkmcnt(12)
    v_fma_f32 v254, v224, s74, -v254
    v_max_f32 v254, 0, v254
    v_add_f32 v254, 0x3d27c5ac, v254
    v_rsq_f32 v254, v254
    ds_read_b64_tr_b16 v[164:165], v227 offset:0
    v_mul_f32 v254, v254, v255
    ds_read_b64_tr_b16 v[140:141], v227 offset:512
    v_xor_b32 v227, 96, v240
    v_max_f32_dpp v224, v254, v254 quad_perm:[1,0,3,2] row_mask:0xf bank_mask:0xf
    ds_read_b64_tr_b16 v[148:149], v239 offset:0
    ds_read_b64_tr_b16 v[150:151], v240 offset:0
    v_max_f32_dpp v224, v224, v224 quad_perm:[2,3,0,1] row_mask:0xf bank_mask:0xf
    ds_read_b64_tr_b16 v[166:167], v227 offset:0
    ds_read_b64_tr_b16 v[168:169], v239 offset:512
    v_max_f32_dpp v224, v224, v224 row_half_mirror row_mask:0xf bank_mask:0xf
    v_sub_f32 v254, v254, v224
    v_exp_f32 v254, v254
    ds_read_b64_tr_b16 v[170:171], v240 offset:512
    ds_read_b64_tr_b16 v[142:143], v227 offset:512
    v_add_f32_dpp v224, v254, v254 quad_perm:[1,0,3,2] row_mask:0xf bank_mask:0xf
    ds_read_b32 v255, v246
    s_nop 0
    v_add_f32_dpp v224, v224, v224 quad_perm:[2,3,0,1] row_mask:0xf bank_mask:0xf
    s_nop 1
    v_add_f32_dpp v224, v224, v224 row_half_mirror row_mask:0xf bank_mask:0xf
    v_rcp_f32 v224, v224
    s_nop 0
    v_mul_f32 v254, v254, v224
    v_cvt_pk_bf16_f32 v254, v254, v254
    ds_write_b16 v243, v254
    v_and_b32 v254, 0xffff0000, v254
    v_mul_f32 v254, v254, v252
    v_lshlrev_b32 v224, 3, v225
    ds_read_b128 v[52:55], v244
    v_add_f32_dpp v254, v254, v254 quad_perm:[1,0,3,2] row_mask:0xf bank_mask:0xf
    ds_read_b128 v[24:27], v245
    s_nop 0
    v_add_f32_dpp v254, v254, v254 quad_perm:[2,3,0,1] row_mask:0xf bank_mask:0xf
    s_nop 1
    v_add_f32_dpp v254, v254, v254 row_half_mirror row_mask:0xf bank_mask:0xf
    ds_bpermute_b32 v48, v224, v254
    s_waitcnt lgkmcnt(4)
    v_or_b32 v255, v255, v253
    s_waitcnt lgkmcnt(0)
    v_mov_b32 v49, v48
    v_mov_b32 v50, v48
    v_mov_b32 v51, v48
    s_nop 1
    v_mfma_f32_16x16x32_bf16 v[248:251], v[148:151], v[52:55], v[48:51]
    v_mfma_f32_16x16x32_bf16 v[0:3], v[156:159], v[52:55], v[48:51]
    v_mfma_f32_16x16x32_bf16 v[56:59], v[160:163], v[52:55], v[48:51]
    v_mfma_f32_16x16x32_bf16 v[60:63], v[164:167], v[52:55], v[48:51]
    v_mfma_f32_16x16x32_bf16 v[248:251], v[168:171], v[24:27], v[248:251]
    v_mfma_f32_16x16x32_bf16 v[0:3], v[172:175], v[24:27], v[0:3]
    v_mfma_f32_16x16x32_bf16 v[56:59], v[136:139], v[24:27], v[56:59]
    v_mfma_f32_16x16x32_bf16 v[60:63], v[140:143], v[24:27], v[60:63]
    s_nop 6
    v_cndmask_b32 v248, v248, v56, s[78:79]
    v_cndmask_b32 v249, v249, v57, s[78:79]
    v_cvt_pk_bf16_f32 v148, v248, v249
    v_cndmask_b32 v250, v250, v58, s[78:79]
    v_cndmask_b32 v251, v251, v59, s[78:79]
    v_cvt_pk_bf16_f32 v149, v250, v251
    v_cndmask_b32 v0, v0, v60, s[78:79]
    v_cndmask_b32 v1, v1, v61, s[78:79]
    v_cndmask_b32 v2, v2, v62, s[78:79]
    v_cndmask_b32 v3, v3, v63, s[78:79]
    v_cvt_pk_bf16_f32 v150, v0, v1
    v_cvt_pk_bf16_f32 v151, v2, v3
    s_nop 0
    v_permlane16_swap_b32 v148, v150
    v_permlane16_swap_b32 v149, v151
    buffer_store_dwordx4 v[148:151], v255, s[20:23], 0 offen sc1
    s_branch ATT_END
ATT_HELPER:
    s_setprio 1
    s_movk_i32 s69, 3
ATT_HWAIT:
    s_lshl_b32 s62, s7, 2
    s_add_u32 s62, s62, 161984
    v_mov_b32 v24, s62
    ds_read_b32 v24, v24
    s_waitcnt lgkmcnt(0)
    v_readfirstlane_b32 s62, v24
    s_cmp_eq_u32 s62, 7
    s_cbranch_scc1 ATT_HGO
    s_sleep 1
    s_add_u32 s77, s77, 1
    s_cmp_gt_u32 s77, 16777216
    s_cbranch_scc0 ATT_HWAIT
    s_endpgm
ATT_HGO:
ATT_BODY:
    s_mov_b32 vcc_lo, 0x00ff00ff
    s_mov_b32 vcc_hi, 0xff00ff00
    s_mov_b32 s78, 0xff00ff00
    s_mov_b32 s79, 0xff00ff00
    ds_read_b128 v[8:11], v229 offset:0
    ds_read_b128 v[16:19], v229 offset:256
    ds_read_b128 v[12:15], v230 offset:0
    ds_read_b128 v[20:23], v230 offset:256
    ds_read_b128 v[4:7], v242 offset:0
    ds_read_b32 v252, v241 offset:0
    ds_read_b64_tr_b16 v[150:151], v231 offset:0
    ds_read_b64_tr_b16 v[170:171], v231 offset:256
    ds_read_b64_tr_b16 v[158:159], v232 offset:0
    ds_read_b64_tr_b16 v[174:175], v232 offset:256
    ds_read_b64_tr_b16 v[162:163], v233 offset:0
    ds_read_b64_tr_b16 v[166:167], v234 offset:0
    ds_read_b64_tr_b16 v[138:139], v233 offset:256
    ds_read_b64_tr_b16 v[142:143], v234 offset:256
    v_lshl_add_u32 v227, v243, 1, s72
    s_waitcnt lgkmcnt(13)
    v_mfma_f32_16x16x32_bf16 v[24:27], v[64:67], v[8:11], 0
    v_mfma_f32_16x16x32_bf16 v[28:31], v[72:75], v[8:11], 0
    s_waitcnt lgkmcnt(12)
    v_mfma_f32_16x16x32_bf16 v[40:43], v[64:67], v[16:19], 0
    v_mfma_f32_16x16x32_bf16 v[44:47], v[72:75], v[16:19], 0
    v_mfma_f32_16x16x32_bf16 v[32:35], v[80:83], v[8:11], 0
    v_mfma_f32_16x16x32_bf16 v[36:39], v[88:91], v[8:11], 0
    v_mfma_f32_16x16x32_bf16 v[48:51], v[80:83], v[16:19], 0
    v_mfma_f32_16x16x32_bf16 v[52:55], v[88:91], v[16:19], 0
    s_waitcnt lgkmcnt(11)
    v_mfma_f32_16x16x32_bf16 v[24:27], v[68:71], v[12:15], v[24:27]
    v_mfma_f32_16x16x32_bf16 v[28:31], v[76:79], v[12:15], v[28:31]
    s_waitcnt lgkmcnt(10)
    v_mfma_f32_16x16x32_bf16 v[40:43], v[68:71], v[20:23], v[40:43]
    v_mfma_f32_16x16x32_bf16 v[44:47], v[76:79], v[20:23], v[44:47]
    v_mfma_f32_16x16x32_bf16 v[32:35], v[84:87], v[12:15], v[32:35]
    v_mfma_f32_16x16x32_bf16 v[36:39], v[92:95], v[12:15], v[36:39]
    v_mfma_f32_16x16x32_bf16 v[48:51], v[84:87], v[20:23], v[48:51]
    v_mfma_f32_16x16x32_bf16 v[52:55], v[92:95], v[20:23], v[52:55]
    v_cvt_pk_bf16_f32 v56, v24, v25
    v_cvt_pk_bf16_f32 v57, v26, v27
    v_cvt_pk_bf16_f32 v58, v28, v29
    v_cvt_pk_bf16_f32 v59, v30, v31
    v_cvt_pk_bf16_f32 v128, v40, v41
    v_cvt_pk_bf16_f32 v129, v42, v43
    v_mfma_f32_16x16x32_bf16 v[248:251], v[8:11], v[56:59], 0
    v_cvt_pk_bf16_f32 v130, v44, v45
    v_cvt_pk_bf16_f32 v131, v46, v47
    v_cvt_pk_bf16_f32 v60, v32, v33
    v_cvt_pk_bf16_f32 v61, v34, v35
    v_mfma_f32_16x16x32_bf16 v[0:3], v[16:19], v[128:131], 0
    v_cvt_pk_bf16_f32 v62, v36, v37
    v_cvt_pk_bf16_f32 v63, v38, v39
    v_cvt_pk_bf16_f32 v132, v48, v49
    v_cvt_pk_bf16_f32 v133, v50, v51
    v_mfma_f32_16x16x32_bf16 v[248:251], v[12:15], v[60:63], v[248:251]
    v_cvt_pk_bf16_f32 v134, v52, v53
    v_cvt_pk_bf16_f32 v135, v54, v55
    s_nop 1
    v_mfma_f32_16x16x32_bf16 v[0:3], v[20:23], v[132:135], v[0:3]
    v_mfma_f32_16x16x32_bf16 v[24:27], v[8:11], v[96:99], 0
    v_mfma_f32_16x16x32_bf16 v[24:27], v[12:15], v[100:103], v[24:27]
    v_mfma_f32_16x16x32_bf16 v[28:31], v[8:11], v[104:107], 0
    v_mfma_f32_16x16x32_bf16 v[28:31], v[12:15], v[108:111], v[28:31]
    s_nop 3
    v_cndmask_b32_dpp v56, v0, v248, vcc row_ror:8 row_mask:0xf bank_mask:0xf
    v_mfma_f32_16x16x32_bf16 v[32:35], v[8:11], v[112:115], 0
    s_waitcnt lgkmcnt(9)
    v_mul_f32 v56, v56, v4
    v_cndmask_b32_dpp v57, v1, v249, vcc row_ror:8 row_mask:0xf bank_mask:0xf
    v_cndmask_b32_dpp v58, v2, v250, vcc row_ror:8 row_mask:0xf bank_mask:0xf
    v_cndmask_b32_dpp v59, v3, v251, vcc row_ror:8 row_mask:0xf bank_mask:0xf
    v_mfma_f32_16x16x32_bf16 v[32:35], v[12:15], v[116:119], v[32:35]
    v_mul_f32 v57, v57, v5
    v_mul_f32 v58, v58, v6
    v_mul_f32 v59, v59, v7
    v_max3_f32 v60, v56, v57, v58
    v_max_f32 v60, v60, v59
    v_mfma_f32_16x16x32_bf16 v[36:39], v[8:11], v[120:123], 0
    ds_swizzle_b32 v61, v60 offset:0x401f
    ds_read_b128 v[8:11], v229 offset:512
    v_cvt_pk_bf16_f32 v148, v24, v25
    v_cvt_pk_bf16_f32 v149, v26, v27
    v_mfma_f32_16x16x32_bf16 v[36:39], v[12:15], v[124:127], v[36:39]
    ds_read_b128 v[12:15], v230 offset:512
    v_cvt_pk_bf16_f32 v156, v28, v29
    v_cvt_pk_bf16_f32 v157, v30, v31
    v_cvt_pk_bf16_f32 v160, v32, v33
    v_mfma_f32_16x16x32_bf16 v[40:43], v[16:19], v[96:99], 0
    v_cvt_pk_bf16_f32 v161, v34, v35
    s_nop 1
    v_cvt_pk_bf16_f32 v164, v36, v37
    v_mfma_f32_16x16x32_bf16 v[40:43], v[20:23], v[100:103], v[40:43]
    v_cvt_pk_bf16_f32 v165, v38, v39
    v_mfma_f32_16x16x32_bf16 v[44:47], v[16:19], v[104:107], 0
    s_waitcnt lgkmcnt(2)
    v_max_f32 v60, v60, v61
    v_mul_f32 v60, v60, v252
    v_fma_f32 v56, v56, v252, -v60
    v_fma_f32 v57, v57, v252, -v60
    v_fma_f32 v58, v58, v252, -v60
    v_mfma_f32_16x16x32_bf16 v[44:47], v[20:23], v[108:111], v[44:47]
    v_fma_f32 v59, v59, v252, -v60
    v_exp_f32 v56, v56
    v_exp_f32 v57, v57
    v_mfma_f32_16x16x32_bf16 v[48:51], v[16:19], v[112:115], 0
    v_exp_f32 v58, v58
    v_exp_f32 v59, v59
    v_add_f32 v62, v56, v57
    v_mfma_f32_16x16x32_bf16 v[48:51], v[20:23], v[116:119], v[48:51]
    v_add_f32 v63, v58, v59
    v_add_f32 v62, v62, v63
    ds_swizzle_b32 v63, v62 offset:0x401f
    v_mul_f32 v56, v56, v4
    v_mul_f32 v57, v57, v5
    v_mfma_f32_16x16x32_bf16 v[52:55], v[16:19], v[120:123], 0
    ds_read_b128 v[16:19], v229 offset:768
    v_mul_f32 v58, v58, v6
    v_mul_f32 v59, v59, v7
    v_cvt_pk_bf16_f32 v168, v40, v41
    v_mfma_f32_16x16x32_bf16 v[52:55], v[20:23], v[124:127], v[52:55]
    ds_read_b128 v[20:23], v230 offset:768
    v_cvt_pk_bf16_f32 v169, v42, v43
    v_cvt_pk_bf16_f32 v172, v44, v45
    v_cvt_pk_bf16_f32 v173, v46, v47
    v_cvt_pk_bf16_f32 v136, v48, v49
    v_cvt_pk_bf16_f32 v137, v50, v51
    ds_read_b128 v[4:7], v242 offset:128
    ds_read_b32 v252, v241 offset:128
    v_cvt_pk_bf16_f32 v140, v52, v53
    v_cvt_pk_bf16_f32 v141, v54, v55
    v_add_u32 v241, s75, v241
    v_add_u32 v242, s75, v242
    s_waitcnt lgkmcnt(4)
    v_add_f32 v62, v62, v63
    v_rcp_f32 v62, v62
    s_nop 0
    v_mul_f32 v56, v56, v62
    v_mul_f32 v57, v57, v62
    v_mul_f32 v58, v58, v62
    v_mul_f32 v59, v59, v62
    v_cvt_pk_bf16_f32 v216, v56, v57
    v_cvt_pk_bf16_f32 v217, v58, v59
    s_nop 0
    v_and_b32_dpp v220, v216, v228 row_ror:8 row_mask:0xf bank_mask:0xf
    v_and_b32 v216, v216, v228
    v_and_b32_dpp v221, v217, v228 row_ror:8 row_mask:0xf bank_mask:0xf
    v_and_b32 v217, v217, v228
    s_nop 0
    v_mfma_f32_16x16x32_bf16 v[40:43], v[168:171], v[220:223], 0
    v_mfma_f32_16x16x32_bf16 v[24:27], v[148:151], v[216:219], 0
    v_mfma_f32_16x16x32_bf16 v[44:47], v[172:175], v[220:223], 0
    v_mfma_f32_16x16x32_bf16 v[28:31], v[156:159], v[216:219], 0
    v_mfma_f32_16x16x32_bf16 v[48:51], v[136:139], v[220:223], 0
    v_mfma_f32_16x16x32_bf16 v[52:55], v[140:143], v[220:223], 0
    v_mfma_f32_16x16x32_bf16 v[32:35], v[160:163], v[216:219], 0
    v_mfma_f32_16x16x32_bf16 v[36:39], v[164:167], v[216:219], 0
    s_nop 0
    v_cvt_pk_bf16_f32 v168, v40, v41
    v_cvt_pk_bf16_f32 v169, v42, v43
    s_waitcnt lgkmcnt(3)
    v_mfma_f32_16x16x32_bf16 v[40:43], v[64:67], v[16:19], 0
    v_cvt_pk_bf16_f32 v148, v24, v25
    v_cvt_pk_bf16_f32 v149, v26, v27
    v_mfma_f32_16x16x32_bf16 v[24:27], v[64:67], v[8:11], 0
    v_cvt_pk_bf16_f32 v150, v28, v29
    v_cvt_pk_bf16_f32 v151, v30, v31
    v_mfma_f32_16x16x32_bf16 v[28:31], v[72:75], v[8:11], 0
    v_cvt_pk_bf16_f32 v170, v44, v45
    v_cvt_pk_bf16_f32 v171, v46, v47
    v_mfma_f32_16x16x32_bf16 v[44:47], v[72:75], v[16:19], 0
    v_cvt_pk_bf16_f32 v156, v32, v33
    v_cvt_pk_bf16_f32 v157, v34, v35
    v_mfma_f32_16x16x32_bf16 v[24:27], v[68:71], v[12:15], v[24:27]
    v_cvt_pk_bf16_f32 v158, v36, v37
    v_cvt_pk_bf16_f32 v159, v38, v39
    v_mfma_f32_16x16x32_bf16 v[28:31], v[76:79], v[12:15], v[28:31]
    v_cvt_pk_bf16_f32 v172, v48, v49
    v_cvt_pk_bf16_f32 v173, v50, v51
    v_mfma_f32_16x16x32_bf16 v[32:35], v[80:83], v[8:11], 0
    v_cvt_pk_bf16_f32 v174, v52, v53
    v_cvt_pk_bf16_f32 v175, v54, v55
    v_mfma_f32_16x16x32_bf16 v[36:39], v[88:91], v[8:11], 0
    v_cvt_pk_bf16_f32 v56, v24, v25
    v_cvt_pk_bf16_f32 v57, v26, v27
    s_waitcnt lgkmcnt(2)
    v_mfma_f32_16x16x32_bf16 v[40:43], v[68:71], v[20:23], v[40:43]
    v_cvt_pk_bf16_f32 v58, v28, v29
    v_cvt_pk_bf16_f32 v59, v30, v31
    v_mfma_f32_16x16x32_bf16 v[44:47], v[76:79], v[20:23], v[44:47]
    ds_write_b64 v236, v[150:151] offset:0
    v_mfma_f32_16x16x32_bf16 v[48:51], v[80:83], v[16:19], 0
    ds_write_b64 v236, v[170:171] offset:256
    v_mfma_f32_16x16x32_bf16 v[52:55], v[88:91], v[16:19], 0
    ds_write_b64 v238, v[158:159] offset:0
    v_mfma_f32_16x16x32_bf16 v[32:35], v[84:87], v[12:15], v[32:35]
    v_cvt_pk_bf16_f32 v128, v40, v41
    v_cvt_pk_bf16_f32 v129, v42, v43
    v_mfma_f32_16x16x32_bf16 v[36:39], v[92:95], v[12:15], v[36:39]
    v_cvt_pk_bf16_f32 v130, v44, v45
    v_cvt_pk_bf16_f32 v131, v46, v47
    v_mfma_f32_16x16x32_bf16 v[48:51], v[84:87], v[20:23], v[48:51]
    ds_write_b64 v238, v[174:175] offset:256
    v_mfma_f32_16x16x32_bf16 v[52:55], v[92:95], v[20:23], v[52:55]
    v_cvt_pk_bf16_f32 v60, v32, v33
    v_cvt_pk_bf16_f32 v61, v34, v35
    v_mfma_f32_16x16x32_bf16 v[248:251], v[8:11], v[56:59], 0
    v_cvt_pk_bf16_f32 v62, v36, v37
    v_cvt_pk_bf16_f32 v63, v38, v39
    v_mfma_f32_16x16x32_bf16 v[0:3], v[16:19], v[128:131], 0
    v_cvt_pk_bf16_f32 v132, v48, v49
    v_cvt_pk_bf16_f32 v133, v50, v51
    v_mfma_f32_16x16x32_bf16 v[248:251], v[12:15], v[60:63], v[248:251]
    v_cvt_pk_bf16_f32 v134, v52, v53
    v_cvt_pk_bf16_f32 v135, v54, v55
    v_mfma_f32_16x16x32_bf16 v[160:163], v[148:151], v[148:151], 0
    ds_write_b64 v235, v[148:149] offset:0
    v_mfma_f32_16x16x32_bf16 v[0:3], v[20:23], v[132:135], v[0:3]
    ds_write_b64 v235, v[168:169] offset:256
    v_mfma_f32_16x16x32_bf16 v[24:27], v[8:11], v[96:99], 0
    ds_write_b64 v237, v[156:157] offset:0
    v_mfma_f32_16x16x32_bf16 v[136:139], v[168:171], v[168:171], 0
    ds_write_b64 v237, v[172:173] offset:256
    v_mfma_f32_16x16x32_bf16 v[24:27], v[12:15], v[100:103], v[24:27]
    s_nop 1
    v_cndmask_b32_dpp v56, v0, v248, vcc row_ror:8 row_mask:0xf bank_mask:0xf
    v_mfma_f32_16x16x32_bf16 v[164:167], v[208:211], v[148:151], 0
    v_cndmask_b32_dpp v57, v1, v249, vcc row_ror:8 row_mask:0xf bank_mask:0xf
    v_cndmask_b32_dpp v58, v2, v250, vcc row_ror:8 row_mask:0xf bank_mask:0xf
    v_mfma_f32_16x16x32_bf16 v[28:31], v[8:11], v[104:107], 0
    v_cndmask_b32_dpp v59, v3, v251, vcc row_ror:8 row_mask:0xf bank_mask:0xf
    s_waitcnt lgkmcnt(9)
    v_mul_f32 v56, v56, v4
    v_mfma_f32_16x16x32_bf16 v[140:143], v[208:211], v[168:171], 0
    v_mul_f32 v57, v57, v5
    v_mul_f32 v58, v58, v6
    v_mfma_f32_16x16x32_bf16 v[28:31], v[12:15], v[108:111], v[28:31]
    v_mul_f32 v59, v59, v7
    v_max3_f32 v60, v56, v57, v58
    v_mfma_f32_16x16x32_bf16 v[160:163], v[156:159], v[156:159], v[160:163]
    v_max_f32 v60, v60, v59
    ds_swizzle_b32 v61, v60 offset:0x401f
    v_mfma_f32_16x16x32_bf16 v[32:35], v[8:11], v[112:115], 0
    ds_read_b64_tr_b16 v[150:151], v231 offset:512
    ds_read_b64_tr_b16 v[170:171], v231 offset:768
    v_mfma_f32_16x16x32_bf16 v[136:139], v[172:175], v[172:175], v[136:139]
    v_cvt_pk_bf16_f32 v148, v24, v25
    v_cvt_pk_bf16_f32 v149, v26, v27
    v_mfma_f32_16x16x32_bf16 v[32:35], v[12:15], v[116:119], v[32:35]
    v_cndmask_b32 v160, v160, v161, s[88:89]
    v_cndmask_b32 v162, v162, v163, s[88:89]
    v_mfma_f32_16x16x32_bf16 v[164:167], v[212:215], v[156:159], v[164:167]
    ds_read_b64_tr_b16 v[158:159], v232 offset:512
    v_cndmask_b32 v160, v160, v162, s[90:91]
    v_mfma_f32_16x16x32_bf16 v[36:39], v[8:11], v[120:123], 0
    v_cndmask_b32 v136, v136, v137, s[88:89]
    v_cndmask_b32 v138, v138, v139, s[88:89]
    v_mfma_f32_16x16x32_bf16 v[140:143], v[212:215], v[172:175], v[140:143]
    ds_read_b64_tr_b16 v[174:175], v232 offset:768
    v_cndmask_b32 v136, v136, v138, s[90:91]
    v_mfma_f32_16x16x32_bf16 v[36:39], v[12:15], v[124:127], v[36:39]
    ds_read_b64_tr_b16 v[162:163], v233 offset:512
    s_waitcnt lgkmcnt(5)
    v_max_f32 v60, v60, v61
    v_mul_f32 v60, v60, v252
    v_fma_f32 v56, v56, v252, -v60
    v_fma_f32 v57, v57, v252, -v60
    v_mfma_f32_16x16x32_bf16 v[40:43], v[16:19], v[96:99], 0
    v_fma_f32 v58, v58, v252, -v60
    v_fma_f32 v59, v59, v252, -v60
    v_exp_f32 v56, v56
    v_exp_f32 v57, v57
    v_mfma_f32_16x16x32_bf16 v[40:43], v[20:23], v[100:103], v[40:43]
    v_exp_f32 v58, v58
    v_exp_f32 v59, v59
    v_add_f32 v62, v56, v57
    v_mfma_f32_16x16x32_bf16 v[44:47], v[16:19], v[104:107], 0
    v_add_f32 v63, v58, v59
    v_add_f32 v62, v62, v63
    ds_swizzle_b32 v63, v62 offset:0x401f
    ds_read_b64_tr_b16 v[166:167], v234 offset:512
    ds_read_b64_tr_b16 v[138:139], v233 offset:768
    v_mfma_f32_16x16x32_bf16 v[44:47], v[20:23], v[108:111], v[44:47]
    ds_read_b64_tr_b16 v[142:143], v234 offset:768
    v_mul_f32 v56, v56, v4
    v_mul_f32 v57, v57, v5
    v_mul_f32 v58, v58, v6
    v_mul_f32 v59, v59, v7
    v_mfma_f32_16x16x32_bf16 v[48:51], v[16:19], v[112:115], 0
    v_cvt_pk_bf16_f32 v168, v40, v41
    v_cvt_pk_bf16_f32 v169, v42, v43
    v_cvt_pk_bf16_f32 v156, v28, v29
    v_cvt_pk_bf16_f32 v157, v30, v31
    v_cvt_pk_bf16_f32 v172, v44, v45
    v_mfma_f32_16x16x32_bf16 v[48:51], v[20:23], v[116:119], v[48:51]
    v_cvt_pk_bf16_f32 v173, v46, v47
    v_mov_b32 v254, v164
    v_mov_b32 v255, v165
    s_mov_b64 exec, s[92:93]
    ds_write_b32 v225, v160 offset:0
    s_mov_b64 exec, -1
    s_mov_b64 exec, s[92:93]
    ds_write_b32 v225, v136 offset:64
    s_mov_b64 exec, -1
    v_mfma_f32_16x16x32_bf16 v[52:55], v[16:19], v[120:123], 0
    v_cndmask_b32 v254, v254, v140, s[94:95]
    v_cndmask_b32 v255, v255, v141, s[94:95]
    s_waitcnt lgkmcnt(5)
    v_add_f32 v62, v62, v63
    v_rcp_f32 v62, v62
    v_mfma_f32_16x16x32_bf16 v[52:55], v[20:23], v[124:127], v[52:55]
    v_mul_f32 v56, v56, v62
    v_mul_f32 v57, v57, v62
    v_mul_f32 v58, v58, v62
    v_mul_f32 v59, v59, v62
    v_cvt_pk_bf16_f32 v216, v56, v57
    v_cvt_pk_bf16_f32 v217, v58, v59
    v_cvt_pk_bf16_f32 v160, v32, v33
    v_and_b32_dpp v220, v216, v228 row_ror:8 row_mask:0xf bank_mask:0xf
    v_and_b32_dpp v221, v217, v228 row_ror:8 row_mask:0xf bank_mask:0xf
    v_and_b32 v216, v216, v228
    v_and_b32 v217, v217, v228
    v_mfma_f32_16x16x32_bf16 v[40:43], v[168:171], v[220:223], 0
    v_cvt_pk_bf16_f32 v161, v34, v35
    v_cvt_pk_bf16_f32 v164, v36, v37
    v_mfma_f32_16x16x32_bf16 v[24:27], v[148:151], v[216:219], 0
    v_cvt_pk_bf16_f32 v165, v38, v39
    v_cvt_pk_bf16_f32 v136, v48, v49
    v_mfma_f32_16x16x32_bf16 v[28:31], v[156:159], v[216:219], 0
    v_cvt_pk_bf16_f32 v137, v50, v51
    v_cvt_pk_bf16_f32 v140, v52, v53
    v_mfma_f32_16x16x32_bf16 v[44:47], v[172:175], v[220:223], 0
    v_cvt_pk_bf16_f32 v141, v54, v55
    v_cvt_pk_bf16_f32 v168, v40, v41
    v_mfma_f32_16x16x32_bf16 v[32:35], v[160:163], v[216:219], 0
    v_cvt_pk_bf16_f32 v148, v24, v25
    v_cvt_pk_bf16_f32 v149, v26, v27
    s_waitcnt lgkmcnt(4)
    v_mfma_f32_16x16x32_bf16 v[36:39], v[164:167], v[216:219], 0
    v_cvt_pk_bf16_f32 v150, v28, v29
    v_cvt_pk_bf16_f32 v151, v30, v31
    s_waitcnt lgkmcnt(3)
    v_mfma_f32_16x16x32_bf16 v[48:51], v[136:139], v[220:223], 0
    v_cvt_pk_bf16_f32 v169, v42, v43
    v_cvt_pk_bf16_f32 v170, v44, v45
    s_waitcnt lgkmcnt(2)
    v_mfma_f32_16x16x32_bf16 v[52:55], v[140:143], v[220:223], 0
    v_cvt_pk_bf16_f32 v171, v46, v47
    v_cvt_pk_bf16_f32 v156, v32, v33
    v_mfma_f32_16x16x32_bf16 v[160:163], v[148:151], v[148:151], 0
    v_cvt_pk_bf16_f32 v157, v34, v35
    v_cvt_pk_bf16_f32 v158, v36, v37
    v_mfma_f32_16x16x32_bf16 v[136:139], v[168:171], v[168:171], 0
    v_cvt_pk_bf16_f32 v159, v38, v39
    v_cvt_pk_bf16_f32 v172, v48, v49
    v_mfma_f32_16x16x32_bf16 v[164:167], v[208:211], v[148:151], 0
    v_cvt_pk_bf16_f32 v173, v50, v51
    v_cvt_pk_bf16_f32 v174, v52, v53
    v_mfma_f32_16x16x32_bf16 v[160:163], v[156:159], v[156:159], v[160:163]
    v_cvt_pk_bf16_f32 v175, v54, v55
    ds_read_b32 v252, v226
    v_mfma_f32_16x16x32_bf16 v[140:143], v[208:211], v[168:171], 0
    ds_write_b64 v235, v[148:149] offset:512
    v_mfma_f32_16x16x32_bf16 v[136:139], v[172:175], v[172:175], v[136:139]
    ds_write_b64 v236, v[150:151] offset:512
    v_mfma_f32_16x16x32_bf16 v[164:167], v[212:215], v[156:159], v[164:167]
    ds_write_b64 v237, v[156:157] offset:512
    v_mfma_f32_16x16x32_bf16 v[140:143], v[212:215], v[172:175], v[140:143]
    v_cndmask_b32 v160, v160, v161, s[88:89]
    v_cndmask_b32 v162, v162, v163, s[88:89]
    v_cndmask_b32 v160, v160, v162, s[90:91]
    s_mov_b64 exec, s[92:93]
    ds_write_b32 v225, v160 offset:128
    s_mov_b64 exec, -1
    v_cndmask_b32 v136, v136, v137, s[88:89]
    v_cndmask_b32 v138, v138, v139, s[88:89]
    v_cndmask_b32 v136, v136, v138, s[90:91]
    s_mov_b64 exec, s[92:93]
    ds_write_b32 v225, v136 offset:192
    s_mov_b64 exec, -1
    ds_read_b32 v224, v227
    v_cndmask_b32 v254, v254, v164, s[28:29]
    v_cndmask_b32 v254, v254, v140, s[30:31]
    v_mul_f32 v254, v254, v254
    v_cndmask_b32 v255, v255, v165, s[28:29]
    v_cndmask_b32 v255, v255, v141, s[30:31]
    ds_write_b64 v238, v[158:159] offset:512
    ds_write_b64 v235, v[168:169] offset:768
    ds_write_b64 v236, v[170:171] offset:768
    ds_write_b64 v237, v[172:173] offset:768
    ds_write_b64 v238, v[174:175] offset:768
    v_xor_b32 v227, 32, v239
    s_waitcnt lgkmcnt(11)
    v_lshlrev_b32 v252, 16, v252
    ds_read_b64_tr_b16 v[156:157], v227 offset:0
    ds_read_b64_tr_b16 v[172:173], v227 offset:512
    v_xor_b32 v227, 32, v240
    ds_read_b64_tr_b16 v[158:159], v227 offset:0
    ds_read_b64_tr_b16 v[174:175], v227 offset:512
    v_xor_b32 v227, 64, v239
    ds_read_b64_tr_b16 v[160:161], v227 offset:0
    ds_read_b64_tr_b16 v[136:137], v227 offset:512
    v_xor_b32 v227, 64, v240
    ds_read_b64_tr_b16 v[162:163], v227 offset:0
    s_waitcnt lgkmcnt(12)
    v_fma_f32 v254, v224, s74, -v254
    v_max_f32 v254, 0, v254
    v_add_f32 v254, 0x3d27c5ac, v254
    v_rsq_f32 v254, v254
    ds_read_b64_tr_b16 v[138:139], v227 offset:512
    v_mul_f32 v254, v254, v255
    v_xor_b32 v227, 96, v239
    ds_read_b64_tr_b16 v[164:165], v227 offset:0
    v_max_f32_dpp v224, v254, v254 quad_perm:[1,0,3,2] row_mask:0xf bank_mask:0xf
    ds_read_b64_tr_b16 v[140:141], v227 offset:512
    v_xor_b32 v227, 96, v240
    v_max_f32_dpp v224, v224, v224 quad_perm:[2,3,0,1] row_mask:0xf bank_mask:0xf
    ds_read_b64_tr_b16 v[148:149], v239 offset:0
    ds_read_b64_tr_b16 v[150:151], v240 offset:0
    v_max_f32_dpp v224, v224, v224 row_half_mirror row_mask:0xf bank_mask:0xf
    v_sub_f32 v254, v254, v224
    v_exp_f32 v254, v254
    ds_read_b64_tr_b16 v[166:167], v227 offset:0
    ds_read_b64_tr_b16 v[168:169], v239 offset:512
    v_add_f32_dpp v224, v254, v254 quad_perm:[1,0,3,2] row_mask:0xf bank_mask:0xf
    ds_read_b64_tr_b16 v[170:171], v240 offset:512
    ds_read_b64_tr_b16 v[142:143], v227 offset:512
    v_add_f32_dpp v224, v224, v224 quad_perm:[2,3,0,1] row_mask:0xf bank_mask:0xf
    ds_read_b32 v255, v246
    v_mov_b32 v227, s6
    v_add_f32_dpp v224, v224, v224 row_half_mirror row_mask:0xf bank_mask:0xf
    v_rcp_f32 v224, v224
    v_cndmask_b32 v227, 0, v227, s[32:33]
    v_mul_f32 v254, v254, v224
    v_cvt_pk_bf16_f32 v254, v254, v254
    ds_write_b16 v243, v254
    v_and_b32 v254, 0xffff0000, v254
    v_mul_f32 v254, v254, v252
    v_lshlrev_b32 v224, 3, v225
    ds_read_b128 v[28:31], v244
    v_add_f32_dpp v254, v254, v254 quad_perm:[1,0,3,2] row_mask:0xf bank_mask:0xf
    ds_read_b128 v[32:35], v245
    v_add_u32 v229, v227, v229
    v_add_f32_dpp v254, v254, v254 quad_perm:[2,3,0,1] row_mask:0xf bank_mask:0xf
    v_add_u32 v230, v227, v230
    v_add_u32 v235, v227, v235
    v_add_f32_dpp v254, v254, v254 row_half_mirror row_mask:0xf bank_mask:0xf
    ds_bpermute_b32 v24, v224, v254
    v_add_u32 v236, v227, v236
    v_add_u32 v237, v227, v237
    v_add_u32 v238, v227, v238
    v_mov_b32 v227, s6
    v_cndmask_b32 v227, 0, v227, s[34:35]
    v_add_u32 v231, v227, v231
    v_add_u32 v232, v227, v232
    v_add_u32 v233, v227, v233
    v_add_u32 v234, v227, v234
    v_mov_b32 v227, s6
    s_waitcnt lgkmcnt(4)
    v_or_b32 v255, v255, v253
    v_cndmask_b32 v227, 0, v227, s[60:61]
    v_add_u32 v239, v227, v239
    v_add_u32 v240, s68, v240
    v_add_u32 v226, s75, v226
    v_add_u32 v246, s40, v246
    s_waitcnt lgkmcnt(0)
    v_mov_b32 v25, v24
    v_mov_b32 v26, v24
    v_mov_b32 v27, v24
    s_nop 1
    v_mfma_f32_16x16x32_bf16 v[248:251], v[148:151], v[28:31], v[24:27]
    v_mfma_f32_16x16x32_bf16 v[0:3], v[156:159], v[28:31], v[24:27]
    v_mfma_f32_16x16x32_bf16 v[56:59], v[160:163], v[28:31], v[24:27]
    v_mfma_f32_16x16x32_bf16 v[60:63], v[164:167], v[28:31], v[24:27]
    v_mfma_f32_16x16x32_bf16 v[248:251], v[168:171], v[32:35], v[248:251]
    v_mfma_f32_16x16x32_bf16 v[0:3], v[172:175], v[32:35], v[0:3]
    v_mfma_f32_16x16x32_bf16 v[56:59], v[136:139], v[32:35], v[56:59]
    v_mfma_f32_16x16x32_bf16 v[60:63], v[140:143], v[32:35], v[60:63]
    s_nop 6
    v_cndmask_b32 v248, v248, v56, s[78:79]
    v_cndmask_b32 v249, v249, v57, s[78:79]
    v_cvt_pk_bf16_f32 v148, v248, v249
    v_cndmask_b32 v250, v250, v58, s[78:79]
    v_cndmask_b32 v251, v251, v59, s[78:79]
    v_cvt_pk_bf16_f32 v149, v250, v251
    v_cndmask_b32 v0, v0, v60, s[78:79]
    v_cndmask_b32 v1, v1, v61, s[78:79]
    v_cndmask_b32 v2, v2, v62, s[78:79]
    v_cndmask_b32 v3, v3, v63, s[78:79]
    v_cvt_pk_bf16_f32 v150, v0, v1
    v_cvt_pk_bf16_f32 v151, v2, v3
    s_nop 0
    v_permlane16_swap_b32 v148, v150
    v_permlane16_swap_b32 v149, v151
    buffer_store_dwordx4 v[148:151], v255, s[20:23], 0 offen sc1
    s_add_u32 s7, s7, 1
    s_cmp_lt_u32 s7, 25
    s_cbranch_scc1 ATT_HWAIT
    s_branch ATT_END
ATT_END:
K_END:
    s_endpgm
CODE_END:
.section .rodata,"a"
.p2align 6
.amdhsa_kernel gather_scatter__hybrid_graph_tf_nagphormer__graph_kernel
  .amdhsa_next_free_vgpr 256
  .amdhsa_next_free_sgpr 102
  .amdhsa_accum_offset 256
  .amdhsa_group_segment_fixed_size 0
  .amdhsa_kernarg_size 96
  .amdhsa_user_sgpr_count 2
  .amdhsa_user_sgpr_kernarg_segment_ptr 1
  .amdhsa_system_sgpr_workgroup_id_x 1
  .amdhsa_float_denorm_mode_32 3
.end_amdhsa_kernel
```
